```python
import torch

def _softmax(x, axis=-1):
    return torch.softmax(x, dim=axis)

def _gelu(x):
    return torch.nn.functional.gelu(x, approximate='tanh')

def _silu(x):
    return torch.nn.functional.silu(x)

def _sigmoid(x):
    return torch.sigmoid(x)

def _layernorm(x, axis=-1, eps=1e-05):
    m = x.mean(dim=axis, keepdim=True)
    v = x.var(dim=axis, keepdim=True, unbiased=False)
    return (x - m) / torch.sqrt(v + eps)

def _scatter_add(tgt, idx, src, axis=0):
    return tgt.clone().index_add_(axis, idx, src)

def _segment_sum(src, seg, n):
    out = torch.zeros((n,) + src.shape[1:], dtype=src.dtype)
    return out.index_add_(0, seg, src)

def _pad(x, pw):
    flat = tuple((v for pair in reversed(pw) for v in pair))
    return torch.nn.functional.pad(x, flat)
kernel_name = 'sequential_preLN__ssm_conv_s4d__mixer_gmlp__prompt'

def setup_inputs():

    _w = lambda a: (lambda t: t.to(torch.bfloat16) if t.is_floating_point() else t)(torch.as_tensor(a))

    def _A_setup():
        Bsz, L, D, N = (1, 2048, 640, 128)
        return {'u': _w((lambda *s: torch.randn(*s, dtype=torch.bfloat16) * 0.05)(Bsz, L, D)), 'log_A_real': _w((lambda *s: torch.randn(*s, dtype=torch.bfloat16) * 6.4)(D, N) * 0.5), 'A_imag': _w((lambda *s: torch.randn(*s, dtype=torch.bfloat16) * 0.05)(D, N) * 3.14), 'C_real': _w((lambda *s: torch.randn(*s, dtype=torch.bfloat16) * 0.05)(D, N) / N ** 0.5), 'C_imag': _w((lambda *s: torch.randn(*s, dtype=torch.bfloat16) * 0.05)(D, N) / N ** 0.5), 'log_dt': _w((lambda *s: torch.randn(*s, dtype=torch.bfloat16) * 0.05)(D) * 0.5 - 4.0), 'D_skip': _w((lambda *s: torch.randn(*s, dtype=torch.bfloat16) * 0.05)(D))}
    _A_in = _A_setup()

    def _B_setup():
        B, S, D, F = (1, 2048, 640, 1728)
        Fh = F // 2
        return {'x': _w((lambda *s: torch.randn(*s, dtype=torch.bfloat16) * 0.05)(B, S, D)), 'w_in': _w((lambda *s: torch.randn(*s, dtype=torch.bfloat16) * 0.4)(D, 2 * Fh)), 'w_sp': _w(0.01 * (lambda *s: torch.randn(*s, dtype=torch.bfloat16) * 0.4)(S, S)), 'b_sp': _w(1.0 + 0.01 * (lambda *s: torch.randn(*s, dtype=torch.bfloat16) * 0.05)(S)), 'w_out': _w((lambda *s: torch.randn(*s, dtype=torch.bfloat16) * 0.05)(Fh, D))}
    _B_in = _B_setup()
    return {'A_u': _A_in['u'], 'A_log_A_real': _A_in['log_A_real'], 'A_A_imag': _A_in['A_imag'], 'A_C_real': _A_in['C_real'], 'A_C_imag': _A_in['C_imag'], 'A_log_dt': _A_in['log_dt'], 'A_D_skip': _A_in['D_skip'], 'B_x': _B_in['x'], 'B_w_in': _B_in['w_in'], 'B_w_sp': _B_in['w_sp'], 'B_b_sp': _B_in['b_sp'], 'B_w_out': _B_in['w_out']}

def reference(A_u, A_log_A_real, A_A_imag, A_C_real, A_C_imag, A_log_dt, A_D_skip, B_x, B_w_in, B_w_sp, B_b_sp, B_w_out):

    def _A_ref(u, log_A_real, A_imag, C_real, C_imag, log_dt, D_skip):
        L = u.shape[1]
        dt = torch.exp(log_dt)
        A = -torch.exp(log_A_real) + 1j * A_imag
        C = (C_real + 1j * C_imag) * dt[:, None]
        pos = (lambda x, dt: x.to(dt))(torch.arange(L), log_dt.dtype)
        P = torch.exp((A * dt[:, None])[:, :, None] * pos[None, None, :])
        K = 2.0 * torch.einsum('dn,dnl->dl', C, P).real
        L2 = 2 * L
        u_t = (lambda x, *d: x.permute(*d))(u, 0, 2, 1)
        Kf = (lambda x, *a, **k: torch.fft.rfft(x.float(), *a, **k))(K, L2)
        Uf = (lambda x, *a, **k: torch.fft.rfft(x.float(), *a, **k))(u_t, L2)
        y = (lambda x, *a, **k: torch.fft.irfft(x, *a, **k).to(torch.bfloat16))(Uf * Kf[None, :, :], L2)[:, :, :L]
        y = (lambda x, *d: x.permute(*d))(y, 0, 2, 1)
        return y + u * D_skip[None, None, :]

    def _B_ref(x, w_in, w_sp, b_sp, w_out):
        B, S, D = x.shape
        F = w_in.shape[-1]
        Fh = F // 2
        z = _gelu(torch.einsum('bsd,df->bsf', x, w_in))
        z1 = z[..., :Fh].clone()
        z2 = _layernorm(z[..., Fh:], axis=-1)
        g = torch.einsum('ts,bsf->btf', w_sp, z2) + b_sp[None, :, None]
        return torch.einsum('bsf,fd->bsd', z1 * g, w_out)
    x = A_u
    h = x + _A_ref(_layernorm(x, axis=-1), A_log_A_real, A_A_imag, A_C_real, A_C_imag, A_log_dt, A_D_skip)
    h2 = h + _B_ref(_layernorm(h, axis=-1), B_w_in, B_w_sp, B_b_sp, B_w_out)
    return h2
```

```asm
; @launch kernel=prep_kernel grid=(768,1,1) block=(256,1,1) lds=51328
; @launch kernel=main_kernel grid=(256,1,1) block=(512,1,1) lds=163840
.amdgcn_target "amdgcn-amd-amdhsa--gfx950"
.text
.globl prep_kernel
.p2align 8
.type prep_kernel,@function
prep_kernel:
    s_cmp_ge_u32 s2, 768
    s_cbranch_scc1 A_end
    s_load_dwordx2 s[6:7], s[0:1], 112
    s_load_dwordx2 s[44:45], s[0:1], 104
    v_and_b32 v1, 63, v0
    v_lshrrev_b32 v2, 6, v0
    v_and_b32 v3, 15, v0
    v_readfirstlane_b32 s3, v2
    v_bfe_u32 v4, v0, 4, 2
    s_cmp_ge_u32 s2, 128
    s_cbranch_scc1 AB_notln
    s_load_dwordx2 s[4:5], s[0:1], 0
    s_load_dwordx2 s[8:9], s[0:1], 64
    s_load_dwordx2 s[10:11], s[0:1], 88
    s_load_dwordx2 s[46:47], s[0:1], 72
    s_setprio 3
    s_and_b32 s12, s2, 7
    s_lshl_b32 s12, s12, 4
    s_lshr_b32 s13, s2, 3
    s_add_u32 s12, s12, s13
    v_lshrrev_b32 v5, 4, v0
    s_mul_i32 s13, s12, 20480
    v_mul_u32_u24 v6, 1280, v5
    v_lshl_add_u32 v6, v3, 4, v6
    v_mul_u32_u24 v7, 1344, v5
    v_lshl_add_u32 v7, v3, 4, v7
    s_waitcnt lgkmcnt(0)
    s_mov_b32 s16, s4
    s_mov_b32 s17, s5
    s_mov_b32 s18, 2621440
    s_mov_b32 s19, 0x00020000
    buffer_load_dwordx4 v[8:11], v6, s[16:19], s13 offen offset:0
    buffer_load_dwordx4 v[12:15], v6, s[16:19], s13 offen offset:256
    buffer_load_dwordx4 v[16:19], v6, s[16:19], s13 offen offset:512
    buffer_load_dwordx4 v[20:23], v6, s[16:19], s13 offen offset:768
    buffer_load_dwordx4 v[24:27], v6, s[16:19], s13 offen offset:1024
    s_add_u32 s20, s6, 22478848
    s_addc_u32 s21, s7, 0
    s_mov_b32 s22, 2621440
    s_mov_b32 s23, 0x00020000
    s_add_u32 s24, s6, 7864320
    s_addc_u32 s25, s7, 0
    s_mov_b32 s26, 16384
    s_mov_b32 s27, 0x00020000
    s_add_u32 s28, s6, 7929856
    s_addc_u32 s29, s7, 0
    s_mov_b32 s30, 262144
    s_mov_b32 s31, 0x00020000
    v_lshrrev_b32 v33, 5, v1
    v_bfe_u32 v34, v1, 2, 2
    v_lshl_add_u32 v33, v33, 3, v34
    v_mul_u32_u24 v33, 1344, v33
    v_bfe_u32 v34, v1, 4, 1
    v_lshl_add_u32 v33, v34, 5, v33
    v_and_b32 v35, 3, v1
    v_lshl_add_u32 v33, v35, 3, v33
    v_mul_u32_u24 v35, 320, v2
    v_add_u32 v33, v33, v35
    v_mul_u32_u24 v36, 160, v2
    v_lshl_add_u32 v36, v34, 4, v36
    v_add_u32 v36, v36, v3
    v_lshlrev_b32 v36, 5, v36
    v_lshrrev_b32 v35, 5, v1
    v_lshl_add_u32 v36, v35, 4, v36
    s_mul_i32 s15, s12, 20480
    s_add_u32 s14, s15, 4096
    s_mov_b32 s32, 0x3f803f80
    v_mov_b32 v37, 0
    v_mov_b32 v38, 0
    s_cmp_ge_u32 s2, 80
    s_cbranch_scc1 AB_wlo
    s_and_b32 s50, s2, 15
    s_lshr_b32 s51, s2, 4
    s_lshr_b32 s52, s50, 1
    s_and_b32 s53, s50, 1
    s_lshl_b32 s54, s53, 3
    s_lshl_b32 s55, s53, 1
    s_sub_u32 s55, 8, s55
    s_cmp_eq_u32 s52, 7
    s_cselect_b32 s56, 10, 14
    s_mul_i32 s57, s51, 442368
    s_mul_i32 s58, s52, 224
    s_add_u32 s57, s57, s58
    s_mov_b32 s58, 4682
    s_mov_b32 s59, 3456
    v_mov_b32 v104, 0x40000000
    s_mov_b32 s40, s8
    s_mov_b32 s41, s9
    s_mov_b32 s42, 2211840
    s_mov_b32 s43, 0x00020000
    v_add_u32 v100, 0, v0
    v_mul_u32_u24 v101, s58, v100
    v_lshrrev_b32 v101, 16, v101
    v_mul_u32_u24 v102, 14, v101
    v_sub_u32 v102, v100, v102
    v_mul_u32_u24 v101, s59, v101
    v_add_u32 v103, s54, v102
    v_subrev_u32 v100, 14, v103
    v_min_u32 v103, v103, v100
    v_lshl_add_u32 v101, v103, 4, v101
    v_add_u32 v100, 1728, v101
    v_cmp_gt_u32 vcc, s55, v102
    s_nop 1
    v_cndmask_b32 v101, v101, v100, vcc
    v_cmp_gt_u32 vcc, s56, v103
    s_nop 1
    v_cndmask_b32 v148, v104, v101, vcc
    v_add_u32 v100, 256, v0
    v_mul_u32_u24 v101, s58, v100
    v_lshrrev_b32 v101, 16, v101
    v_mul_u32_u24 v102, 14, v101
    v_sub_u32 v102, v100, v102
    v_mul_u32_u24 v101, s59, v101
    v_add_u32 v103, s54, v102
    v_subrev_u32 v100, 14, v103
    v_min_u32 v103, v103, v100
    v_lshl_add_u32 v101, v103, 4, v101
    v_add_u32 v100, 1728, v101
    v_cmp_gt_u32 vcc, s55, v102
    s_nop 1
    v_cndmask_b32 v101, v101, v100, vcc
    v_cmp_gt_u32 vcc, s56, v103
    s_nop 1
    v_cndmask_b32 v149, v104, v101, vcc
    v_add_u32 v100, 512, v0
    v_mul_u32_u24 v101, s58, v100
    v_lshrrev_b32 v101, 16, v101
    v_mul_u32_u24 v102, 14, v101
    v_sub_u32 v102, v100, v102
    v_mul_u32_u24 v101, s59, v101
    v_add_u32 v103, s54, v102
    v_subrev_u32 v100, 14, v103
    v_min_u32 v103, v103, v100
    v_lshl_add_u32 v101, v103, 4, v101
    v_add_u32 v100, 1728, v101
    v_cmp_gt_u32 vcc, s55, v102
    s_nop 1
    v_cndmask_b32 v101, v101, v100, vcc
    v_cmp_gt_u32 vcc, s56, v103
    s_nop 1
    v_cndmask_b32 v150, v104, v101, vcc
    v_add_u32 v100, 768, v0
    v_mul_u32_u24 v101, s58, v100
    v_lshrrev_b32 v101, 16, v101
    v_mul_u32_u24 v102, 14, v101
    v_sub_u32 v102, v100, v102
    v_mul_u32_u24 v101, s59, v101
    v_add_u32 v103, s54, v102
    v_subrev_u32 v100, 14, v103
    v_min_u32 v103, v103, v100
    v_lshl_add_u32 v101, v103, 4, v101
    v_add_u32 v100, 1728, v101
    v_cmp_gt_u32 vcc, s55, v102
    s_nop 1
    v_cndmask_b32 v101, v101, v100, vcc
    v_cmp_gt_u32 vcc, s56, v103
    s_nop 1
    v_cndmask_b32 v151, v104, v101, vcc
    v_add_u32 v100, 1024, v0
    v_mul_u32_u24 v101, s58, v100
    v_lshrrev_b32 v101, 16, v101
    v_mul_u32_u24 v102, 14, v101
    v_sub_u32 v102, v100, v102
    v_mul_u32_u24 v101, s59, v101
    v_add_u32 v103, s54, v102
    v_subrev_u32 v100, 14, v103
    v_min_u32 v103, v103, v100
    v_lshl_add_u32 v101, v103, 4, v101
    v_add_u32 v100, 1728, v101
    v_cmp_gt_u32 vcc, s55, v102
    s_nop 1
    v_cndmask_b32 v101, v101, v100, vcc
    v_cmp_gt_u32 vcc, s56, v103
    s_nop 1
    v_cndmask_b32 v152, v104, v101, vcc
    v_add_u32 v100, 1280, v0
    v_mul_u32_u24 v101, s58, v100
    v_lshrrev_b32 v101, 16, v101
    v_mul_u32_u24 v102, 14, v101
    v_sub_u32 v102, v100, v102
    v_mul_u32_u24 v101, s59, v101
    v_add_u32 v103, s54, v102
    v_subrev_u32 v100, 14, v103
    v_min_u32 v103, v103, v100
    v_lshl_add_u32 v101, v103, 4, v101
    v_add_u32 v100, 1728, v101
    v_cmp_gt_u32 vcc, s55, v102
    s_nop 1
    v_cndmask_b32 v101, v101, v100, vcc
    v_cmp_gt_u32 vcc, s56, v103
    s_nop 1
    v_cndmask_b32 v153, v104, v101, vcc
    v_add_u32 v100, 1536, v0
    v_mul_u32_u24 v101, s58, v100
    v_lshrrev_b32 v101, 16, v101
    v_mul_u32_u24 v102, 14, v101
    v_sub_u32 v102, v100, v102
    v_mul_u32_u24 v101, s59, v101
    v_add_u32 v103, s54, v102
    v_subrev_u32 v100, 14, v103
    v_min_u32 v103, v103, v100
    v_lshl_add_u32 v101, v103, 4, v101
    v_add_u32 v100, 1728, v101
    v_cmp_gt_u32 vcc, s55, v102
    s_nop 1
    v_cndmask_b32 v101, v101, v100, vcc
    v_cmp_gt_u32 vcc, s56, v103
    s_nop 1
    v_cndmask_b32 v154, v104, v101, vcc
    v_mov_b32 v155, v104
    v_mov_b32 v156, v104
    s_branch AB_wldone
AB_wlo:
    s_sub_u32 s51, s2, 80
    s_and_b32 s50, s51, 7
    s_lshr_b32 s51, s51, 3
    s_mul_i32 s57, s51, 286720
    s_mul_i32 s58, s50, 160
    s_add_u32 s57, s57, s58
    s_mov_b32 s58, 6554
    s_mov_b32 s59, 1280
    s_mov_b32 s40, s10
    s_mov_b32 s41, s11
    s_mov_b32 s42, 1105920
    s_mov_b32 s43, 0x00020000
    v_add_u32 v100, 0, v0
    v_mul_u32_u24 v101, s58, v100
    v_lshrrev_b32 v101, 16, v101
    v_mul_u32_u24 v102, 10, v101
    v_sub_u32 v102, v100, v102
    v_mul_u32_u24 v101, s59, v101
    v_lshl_add_u32 v148, v102, 4, v101
    v_add_u32 v100, 256, v0
    v_mul_u32_u24 v101, s58, v100
    v_lshrrev_b32 v101, 16, v101
    v_mul_u32_u24 v102, 10, v101
    v_sub_u32 v102, v100, v102
    v_mul_u32_u24 v101, s59, v101
    v_lshl_add_u32 v149, v102, 4, v101
    v_add_u32 v100, 512, v0
    v_mul_u32_u24 v101, s58, v100
    v_lshrrev_b32 v101, 16, v101
    v_mul_u32_u24 v102, 10, v101
    v_sub_u32 v102, v100, v102
    v_mul_u32_u24 v101, s59, v101
    v_lshl_add_u32 v150, v102, 4, v101
    v_add_u32 v100, 768, v0
    v_mul_u32_u24 v101, s58, v100
    v_lshrrev_b32 v101, 16, v101
    v_mul_u32_u24 v102, 10, v101
    v_sub_u32 v102, v100, v102
    v_mul_u32_u24 v101, s59, v101
    v_lshl_add_u32 v151, v102, 4, v101
    v_add_u32 v100, 1024, v0
    v_mul_u32_u24 v101, s58, v100
    v_lshrrev_b32 v101, 16, v101
    v_mul_u32_u24 v102, 10, v101
    v_sub_u32 v102, v100, v102
    v_mul_u32_u24 v101, s59, v101
    v_lshl_add_u32 v152, v102, 4, v101
    v_add_u32 v100, 1280, v0
    v_mul_u32_u24 v101, s58, v100
    v_lshrrev_b32 v101, 16, v101
    v_mul_u32_u24 v102, 10, v101
    v_sub_u32 v102, v100, v102
    v_mul_u32_u24 v101, s59, v101
    v_lshl_add_u32 v153, v102, 4, v101
    v_add_u32 v100, 1536, v0
    v_mul_u32_u24 v101, s58, v100
    v_lshrrev_b32 v101, 16, v101
    v_mul_u32_u24 v102, 10, v101
    v_sub_u32 v102, v100, v102
    v_mul_u32_u24 v101, s59, v101
    v_lshl_add_u32 v154, v102, 4, v101
    v_add_u32 v100, 1792, v0
    v_mul_u32_u24 v101, s58, v100
    v_lshrrev_b32 v101, 16, v101
    v_mul_u32_u24 v102, 10, v101
    v_sub_u32 v102, v100, v102
    v_mul_u32_u24 v101, s59, v101
    v_lshl_add_u32 v155, v102, 4, v101
    v_add_u32 v100, 2048, v0
    v_mul_u32_u24 v101, s58, v100
    v_lshrrev_b32 v101, 16, v101
    v_mul_u32_u24 v102, 10, v101
    v_sub_u32 v102, v100, v102
    v_mul_u32_u24 v101, s59, v101
    v_lshl_add_u32 v156, v102, 4, v101
AB_wldone:
    s_waitcnt vmcnt(4)
    ds_write_b128 v7, v[8:11] offset:0
    s_waitcnt vmcnt(3)
    ds_write_b128 v7, v[12:15] offset:256
    s_waitcnt vmcnt(2)
    ds_write_b128 v7, v[16:19] offset:512
    s_waitcnt vmcnt(1)
    ds_write_b128 v7, v[20:23] offset:768
    s_waitcnt vmcnt(0)
    ds_write_b128 v7, v[24:27] offset:1024
    s_waitcnt lgkmcnt(0)
    s_barrier
    ds_read_b64_tr_b16 v[84:85], v33 offset:0
    ds_read_b64_tr_b16 v[86:87], v33 offset:5376
    ds_read_b64_tr_b16 v[88:89], v33 offset:64
    ds_read_b64_tr_b16 v[90:91], v33 offset:5440
    ds_read_b64_tr_b16 v[92:93], v33 offset:128
    ds_read_b64_tr_b16 v[94:95], v33 offset:5504
    ds_read_b64_tr_b16 v[96:97], v33 offset:192
    ds_read_b64_tr_b16 v[98:99], v33 offset:5568
    ds_read_b64_tr_b16 v[100:101], v33 offset:256
    ds_read_b64_tr_b16 v[102:103], v33 offset:5632
    v_dot2_f32_bf16 v37, v8, s32, v37
    v_dot2_f32_bf16 v38, v9, s32, v38
    v_dot2_f32_bf16 v37, v10, s32, v37
    v_dot2_f32_bf16 v38, v11, s32, v38
    v_dot2_f32_bf16 v37, v12, s32, v37
    v_dot2_f32_bf16 v38, v13, s32, v38
    v_dot2_f32_bf16 v37, v14, s32, v37
    v_dot2_f32_bf16 v38, v15, s32, v38
    s_waitcnt lgkmcnt(8)
    buffer_store_dwordx4 v[84:87], v36, s[20:23], s15 offen offset:0 sc1
    s_waitcnt lgkmcnt(6)
    buffer_store_dwordx4 v[88:91], v36, s[20:23], s15 offen offset:1024 sc1
    s_waitcnt lgkmcnt(4)
    buffer_store_dwordx4 v[92:95], v36, s[20:23], s15 offen offset:2048 sc1
    s_waitcnt lgkmcnt(2)
    buffer_store_dwordx4 v[96:99], v36, s[20:23], s15 offen offset:3072 sc1
    s_waitcnt lgkmcnt(0)
    buffer_store_dwordx4 v[100:103], v36, s[20:23], s14 offen offset:0 sc1
    v_dot2_f32_bf16 v37, v16, s32, v37
    v_dot2_f32_bf16 v38, v17, s32, v38
    v_dot2_f32_bf16 v37, v18, s32, v37
    v_dot2_f32_bf16 v38, v19, s32, v38
    v_dot2_f32_bf16 v37, v20, s32, v37
    v_dot2_f32_bf16 v38, v21, s32, v38
    v_dot2_f32_bf16 v37, v22, s32, v37
    v_dot2_f32_bf16 v38, v23, s32, v38
    v_dot2_f32_bf16 v37, v24, s32, v37
    v_dot2_f32_bf16 v38, v25, s32, v38
    v_dot2_f32_bf16 v37, v26, s32, v37
    v_dot2_f32_bf16 v38, v27, s32, v38
    v_lshlrev_b32 v40, 16, v8
    v_and_b32 v41, 0xffff0000, v8
    v_lshlrev_b32 v42, 16, v9
    v_and_b32 v43, 0xffff0000, v9
    v_lshlrev_b32 v44, 16, v10
    v_and_b32 v45, 0xffff0000, v10
    v_lshlrev_b32 v46, 16, v11
    v_and_b32 v47, 0xffff0000, v11
    v_lshlrev_b32 v48, 16, v12
    v_and_b32 v49, 0xffff0000, v12
    v_lshlrev_b32 v50, 16, v13
    v_and_b32 v51, 0xffff0000, v13
    v_lshlrev_b32 v52, 16, v14
    v_and_b32 v53, 0xffff0000, v14
    v_lshlrev_b32 v54, 16, v15
    v_and_b32 v55, 0xffff0000, v15
    v_lshlrev_b32 v56, 16, v16
    v_and_b32 v57, 0xffff0000, v16
    v_lshlrev_b32 v58, 16, v17
    v_and_b32 v59, 0xffff0000, v17
    v_lshlrev_b32 v60, 16, v18
    v_and_b32 v61, 0xffff0000, v18
    v_lshlrev_b32 v62, 16, v19
    v_and_b32 v63, 0xffff0000, v19
    v_lshlrev_b32 v64, 16, v20
    v_and_b32 v65, 0xffff0000, v20
    v_lshlrev_b32 v66, 16, v21
    v_and_b32 v67, 0xffff0000, v21
    v_lshlrev_b32 v68, 16, v22
    v_and_b32 v69, 0xffff0000, v22
    v_lshlrev_b32 v70, 16, v23
    v_and_b32 v71, 0xffff0000, v23
    v_lshlrev_b32 v72, 16, v24
    v_and_b32 v73, 0xffff0000, v24
    v_lshlrev_b32 v74, 16, v25
    v_and_b32 v75, 0xffff0000, v25
    v_lshlrev_b32 v76, 16, v26
    v_and_b32 v77, 0xffff0000, v26
    v_lshlrev_b32 v78, 16, v27
    v_and_b32 v79, 0xffff0000, v27
    v_add_f32 v37, v37, v38
    s_nop 1
    v_add_f32_dpp v37, v37, v37 row_ror:8 row_mask:0xf bank_mask:0xf
    s_nop 1
    v_add_f32_dpp v37, v37, v37 row_ror:4 row_mask:0xf bank_mask:0xf
    s_nop 1
    v_add_f32_dpp v37, v37, v37 row_ror:2 row_mask:0xf bank_mask:0xf
    s_nop 1
    v_add_f32_dpp v37, v37, v37 row_ror:1 row_mask:0xf bank_mask:0xf
    v_mul_f32 v38, 0x3acccccd, v37
    v_mov_b32 v80, 0
    v_mov_b32 v81, 0
    v_mov_b32 v82, 0
    v_mov_b32 v83, 0
    v_pk_add_f32 v[40:41], v[40:41], v[38:39] op_sel:[0,0] op_sel_hi:[1,0] neg_lo:[0,1] neg_hi:[0,1]
    v_pk_add_f32 v[42:43], v[42:43], v[38:39] op_sel:[0,0] op_sel_hi:[1,0] neg_lo:[0,1] neg_hi:[0,1]
    v_pk_add_f32 v[44:45], v[44:45], v[38:39] op_sel:[0,0] op_sel_hi:[1,0] neg_lo:[0,1] neg_hi:[0,1]
    v_pk_fma_f32 v[80:81], v[40:41], v[40:41], v[80:81]
    v_pk_add_f32 v[46:47], v[46:47], v[38:39] op_sel:[0,0] op_sel_hi:[1,0] neg_lo:[0,1] neg_hi:[0,1]
    v_pk_fma_f32 v[82:83], v[42:43], v[42:43], v[82:83]
    v_pk_add_f32 v[48:49], v[48:49], v[38:39] op_sel:[0,0] op_sel_hi:[1,0] neg_lo:[0,1] neg_hi:[0,1]
    v_pk_fma_f32 v[80:81], v[44:45], v[44:45], v[80:81]
    v_pk_add_f32 v[50:51], v[50:51], v[38:39] op_sel:[0,0] op_sel_hi:[1,0] neg_lo:[0,1] neg_hi:[0,1]
    v_pk_fma_f32 v[82:83], v[46:47], v[46:47], v[82:83]
    v_pk_add_f32 v[52:53], v[52:53], v[38:39] op_sel:[0,0] op_sel_hi:[1,0] neg_lo:[0,1] neg_hi:[0,1]
    v_pk_fma_f32 v[80:81], v[48:49], v[48:49], v[80:81]
    v_pk_add_f32 v[54:55], v[54:55], v[38:39] op_sel:[0,0] op_sel_hi:[1,0] neg_lo:[0,1] neg_hi:[0,1]
    v_pk_fma_f32 v[82:83], v[50:51], v[50:51], v[82:83]
    v_pk_add_f32 v[56:57], v[56:57], v[38:39] op_sel:[0,0] op_sel_hi:[1,0] neg_lo:[0,1] neg_hi:[0,1]
    v_pk_fma_f32 v[80:81], v[52:53], v[52:53], v[80:81]
    v_pk_add_f32 v[58:59], v[58:59], v[38:39] op_sel:[0,0] op_sel_hi:[1,0] neg_lo:[0,1] neg_hi:[0,1]
    v_pk_fma_f32 v[82:83], v[54:55], v[54:55], v[82:83]
    v_pk_add_f32 v[60:61], v[60:61], v[38:39] op_sel:[0,0] op_sel_hi:[1,0] neg_lo:[0,1] neg_hi:[0,1]
    v_pk_fma_f32 v[80:81], v[56:57], v[56:57], v[80:81]
    v_pk_add_f32 v[62:63], v[62:63], v[38:39] op_sel:[0,0] op_sel_hi:[1,0] neg_lo:[0,1] neg_hi:[0,1]
    v_pk_fma_f32 v[82:83], v[58:59], v[58:59], v[82:83]
    v_pk_add_f32 v[64:65], v[64:65], v[38:39] op_sel:[0,0] op_sel_hi:[1,0] neg_lo:[0,1] neg_hi:[0,1]
    v_pk_fma_f32 v[80:81], v[60:61], v[60:61], v[80:81]
    v_pk_add_f32 v[66:67], v[66:67], v[38:39] op_sel:[0,0] op_sel_hi:[1,0] neg_lo:[0,1] neg_hi:[0,1]
    v_pk_fma_f32 v[82:83], v[62:63], v[62:63], v[82:83]
    v_pk_add_f32 v[68:69], v[68:69], v[38:39] op_sel:[0,0] op_sel_hi:[1,0] neg_lo:[0,1] neg_hi:[0,1]
    v_pk_fma_f32 v[80:81], v[64:65], v[64:65], v[80:81]
    v_pk_add_f32 v[70:71], v[70:71], v[38:39] op_sel:[0,0] op_sel_hi:[1,0] neg_lo:[0,1] neg_hi:[0,1]
    v_pk_fma_f32 v[82:83], v[66:67], v[66:67], v[82:83]
    v_pk_add_f32 v[72:73], v[72:73], v[38:39] op_sel:[0,0] op_sel_hi:[1,0] neg_lo:[0,1] neg_hi:[0,1]
    v_pk_fma_f32 v[80:81], v[68:69], v[68:69], v[80:81]
    v_pk_add_f32 v[74:75], v[74:75], v[38:39] op_sel:[0,0] op_sel_hi:[1,0] neg_lo:[0,1] neg_hi:[0,1]
    v_pk_fma_f32 v[82:83], v[70:71], v[70:71], v[82:83]
    v_pk_add_f32 v[76:77], v[76:77], v[38:39] op_sel:[0,0] op_sel_hi:[1,0] neg_lo:[0,1] neg_hi:[0,1]
    v_pk_fma_f32 v[80:81], v[72:73], v[72:73], v[80:81]
    v_pk_add_f32 v[78:79], v[78:79], v[38:39] op_sel:[0,0] op_sel_hi:[1,0] neg_lo:[0,1] neg_hi:[0,1]
    v_pk_fma_f32 v[82:83], v[74:75], v[74:75], v[82:83]
    v_pk_fma_f32 v[80:81], v[76:77], v[76:77], v[80:81]
    v_pk_fma_f32 v[82:83], v[78:79], v[78:79], v[82:83]
    v_pk_add_f32 v[80:81], v[80:81], v[82:83]
    v_add_f32 v80, v80, v81
    s_nop 1
    v_add_f32_dpp v80, v80, v80 row_ror:8 row_mask:0xf bank_mask:0xf
    s_nop 1
    v_add_f32_dpp v80, v80, v80 row_ror:4 row_mask:0xf bank_mask:0xf
    s_nop 1
    v_add_f32_dpp v80, v80, v80 row_ror:2 row_mask:0xf bank_mask:0xf
    s_nop 1
    v_add_f32_dpp v80, v80, v80 row_ror:1 row_mask:0xf bank_mask:0xf
    v_mul_f32 v80, 0x3acccccd, v80
    v_cvt_pk_bf16_f32 v80, v80, v80
    v_lshlrev_b32 v80, 16, v80
    v_add_f32 v80, 0x3727c5ac, v80
    v_cvt_pk_bf16_f32 v80, v80, v80
    v_lshlrev_b32 v80, 16, v80
    v_sqrt_f32 v80, v80
    v_cvt_pk_bf16_f32 v38, v38, v38
    v_lshlrev_b32 v38, 16, v38
    v_cvt_pk_bf16_f32 v80, v80, v80
    v_lshlrev_b32 v80, 16, v80
    v_rcp_f32 v80, v80
    v_lshlrev_b32 v63, 2, v5
    v_lshlrev_b32 v62, 2, v1
    s_lshl_b32 s14, s12, 7
    ds_write_b32 v63, v38 offset:21504
    ds_write_b32 v63, v80 offset:21568
    s_waitcnt lgkmcnt(0)
    s_barrier
    s_cmp_lg_u32 s3, 0
    s_cbranch_scc1 AB_lnst
    s_mov_b64 exec, 0xffffffff
    ds_read_b32 v61, v62 offset:21504
    s_waitcnt lgkmcnt(0)
    buffer_store_dword v61, v62, s[24:27], s14 offen sc1
    s_mov_b64 exec, -1
AB_lnst:
    s_waitcnt vmcnt(0)
    v_mov_b32 v5, 0
    v_mov_b32 v6, 1
    s_barrier
    s_cmp_lg_u32 s3, 0
    s_cbranch_scc1 AB_ln1
    s_and_b32 s38, s2, 1
    s_lshl_b32 s38, s38, 7
    v_mov_b32 v8, s38
    s_mov_b64 exec, 1
    global_atomic_add v7, v8, v6, s[44:45] sc0 sc1
    s_mov_b64 exec, -1
AB_ln1:
    buffer_load_dwordx4 v[112:115], v148, s[40:43], s57 offen
    buffer_load_dwordx4 v[116:119], v149, s[40:43], s57 offen
    buffer_load_dwordx4 v[120:123], v150, s[40:43], s57 offen
    buffer_load_dwordx4 v[124:127], v151, s[40:43], s57 offen
    buffer_load_dwordx4 v[128:131], v152, s[40:43], s57 offen
    buffer_load_dwordx4 v[132:135], v153, s[40:43], s57 offen
    buffer_load_dwordx4 v[136:139], v154, s[40:43], s57 offen
    buffer_load_dwordx4 v[140:143], v155, s[40:43], s57 offen
    buffer_load_dwordx4 v[144:147], v156, s[40:43], s57 offen
    s_cmp_lg_u32 s3, 0
    s_cbranch_scc1 AB_lnend
    s_waitcnt vmcnt(9)
    v_readfirstlane_b32 s38, v7
    s_nop 3
    s_cmp_lg_u32 s38, 63
    s_cbranch_scc1 AB_lnend
    v_lshlrev_b32 v7, 7, v1
    v_add_u32 v7, 34832384, v7
    global_atomic_add v7, v6, s[6:7] sc1
    s_mov_b64 exec, 1
    global_atomic_add v5, v6, s[44:45] offset:8 sc1
AB_lnend:
    s_mov_b64 exec, -1
    s_setprio 0
    v_mov_b32 v30, -1
    v_mov_b32 v31, -1
    v_lshlrev_b32 v32, 3, v0
    s_lshl_b32 s14, s2, 11
    buffer_store_dwordx2 v[30:31], v32, s[28:31], s14 offen sc1
    v_mov_b32 v36, 0
    v_mov_b32 v37, 0
    v_mov_b32 v38, 0
    v_mov_b32 v39, 0
    s_lshl_b32 s14, s2, 12
    s_add_u32 s14, s14, 43384832
    v_lshl_add_u32 v33, v0, 4, s14
    global_store_dwordx4 v33, v[36:39], s[6:7] sc1
    v_lshlrev_b32 v100, 4, v0
    v_mov_b32 v101, 0
    v_lshlrev_b32 v102, 2, v0
    s_barrier
    ds_write_b32 v102, v101 offset:36864
    ds_write_b32 v102, v101 offset:37888
    s_waitcnt vmcnt(0)
    ds_write_b128 v100, v[112:115] offset:0
    ds_write_b128 v100, v[116:119] offset:4096
    ds_write_b128 v100, v[120:123] offset:8192
    ds_write_b128 v100, v[124:127] offset:12288
    ds_write_b128 v100, v[128:131] offset:16384
    ds_write_b128 v100, v[132:135] offset:20480
    ds_write_b128 v100, v[136:139] offset:24576
    ds_write_b128 v100, v[140:143] offset:28672
    ds_write_b128 v100, v[144:147] offset:32768
    v_bfe_u32 v5, v1, 2, 4
    v_and_b32 v6, 3, v1
    v_lshlrev_b32 v7, 4, v1
    s_waitcnt lgkmcnt(0)
    s_barrier
    s_cmp_ge_u32 s2, 80
    s_cbranch_scc1 AB_wjo
    v_lshl_add_u32 v5, v2, 5, v5
    v_mul_u32_u24 v5, 224, v5
    v_lshl_add_u32 v5, v6, 3, v5
    ds_read_b64_tr_b16 v[12:13], v5 offset:0
    ds_read_b64_tr_b16 v[14:15], v5 offset:3584
    ds_read_b64_tr_b16 v[16:17], v5 offset:32
    ds_read_b64_tr_b16 v[18:19], v5 offset:3616
    ds_read_b64_tr_b16 v[20:21], v5 offset:64
    ds_read_b64_tr_b16 v[22:23], v5 offset:3648
    ds_read_b64_tr_b16 v[24:25], v5 offset:96
    ds_read_b64_tr_b16 v[26:27], v5 offset:3680
    ds_read_b64_tr_b16 v[28:29], v5 offset:128
    ds_read_b64_tr_b16 v[30:31], v5 offset:3712
    ds_read_b64_tr_b16 v[32:33], v5 offset:160
    ds_read_b64_tr_b16 v[34:35], v5 offset:3744
    ds_read_b64_tr_b16 v[36:37], v5 offset:192
    ds_read_b64_tr_b16 v[38:39], v5 offset:3776
    s_add_u32 s20, s6, 8192000
    s_addc_u32 s21, s7, 0
    s_mov_b32 s22, 2293760
    s_mov_b32 s23, 0x00020000
    s_add_u32 s24, s6, 7880704
    s_addc_u32 s25, s7, 0
    s_mov_b32 s26, 35840
    s_mov_b32 s27, 0x00020000
    s_mul_i32 s42, s50, 10
    s_lshl_b32 s43, s51, 1
    s_add_u32 s42, s42, s43
    s_lshr_b32 s43, s3, 1
    s_add_u32 s42, s42, s43
    s_mul_i32 s42, s42, 14
    s_and_b32 s43, s3, 1
    s_add_u32 s42, s42, s43
    s_lshl_b32 s42, s42, 10
    v_lshlrev_b32 v6, 2, v3
    v_lshl_add_u32 v6, v2, 9, v6
    s_waitcnt lgkmcnt(12)
    s_add_u32 s43, s42, 0
    buffer_store_dwordx4 v[12:15], v7, s[20:23], s43 offen sc1
    s_waitcnt vmcnt(1)
    v_dot2_f32_bf16 v8, v12, s32, 0
    v_dot2_f32_bf16 v8, v13, s32, v8
    v_dot2_f32_bf16 v8, v14, s32, v8
    v_dot2_f32_bf16 v8, v15, s32, v8
    s_nop 2
    ds_add_f32 v6, v8 offset:36864
    s_waitcnt lgkmcnt(11)
    s_add_u32 s43, s42, 2048
    buffer_store_dwordx4 v[16:19], v7, s[20:23], s43 offen sc1
    s_waitcnt vmcnt(1)
    v_dot2_f32_bf16 v8, v16, s32, 0
    v_dot2_f32_bf16 v8, v17, s32, v8
    v_dot2_f32_bf16 v8, v18, s32, v8
    v_dot2_f32_bf16 v8, v19, s32, v8
    s_nop 2
    ds_add_f32 v6, v8 offset:36928
    s_waitcnt lgkmcnt(10)
    s_add_u32 s43, s42, 4096
    buffer_store_dwordx4 v[20:23], v7, s[20:23], s43 offen sc1
    s_waitcnt vmcnt(1)
    v_dot2_f32_bf16 v8, v20, s32, 0
    v_dot2_f32_bf16 v8, v21, s32, v8
    v_dot2_f32_bf16 v8, v22, s32, v8
    v_dot2_f32_bf16 v8, v23, s32, v8
    s_nop 2
    ds_add_f32 v6, v8 offset:36992
    s_waitcnt lgkmcnt(9)
    s_add_u32 s43, s42, 6144
    buffer_store_dwordx4 v[24:27], v7, s[20:23], s43 offen sc1
    s_waitcnt vmcnt(1)
    v_dot2_f32_bf16 v8, v24, s32, 0
    v_dot2_f32_bf16 v8, v25, s32, v8
    v_dot2_f32_bf16 v8, v26, s32, v8
    v_dot2_f32_bf16 v8, v27, s32, v8
    s_nop 2
    ds_add_f32 v6, v8 offset:37056
    s_waitcnt lgkmcnt(8)
    s_add_u32 s43, s42, 8192
    buffer_store_dwordx4 v[28:31], v7, s[20:23], s43 offen sc1
    s_waitcnt vmcnt(1)
    v_dot2_f32_bf16 v8, v28, s32, 0
    v_dot2_f32_bf16 v8, v29, s32, v8
    v_dot2_f32_bf16 v8, v30, s32, v8
    v_dot2_f32_bf16 v8, v31, s32, v8
    s_nop 2
    ds_add_f32 v6, v8 offset:37120
    s_waitcnt lgkmcnt(7)
    s_add_u32 s43, s42, 10240
    buffer_store_dwordx4 v[32:35], v7, s[20:23], s43 offen sc1
    s_waitcnt vmcnt(1)
    v_dot2_f32_bf16 v8, v32, s32, 0
    v_dot2_f32_bf16 v8, v33, s32, v8
    v_dot2_f32_bf16 v8, v34, s32, v8
    v_dot2_f32_bf16 v8, v35, s32, v8
    s_nop 2
    ds_add_f32 v6, v8 offset:37184
    s_waitcnt lgkmcnt(6)
    s_add_u32 s43, s42, 12288
    buffer_store_dwordx4 v[36:39], v7, s[20:23], s43 offen sc1
    s_waitcnt vmcnt(1)
    v_dot2_f32_bf16 v8, v36, s32, 0
    v_dot2_f32_bf16 v8, v37, s32, v8
    v_dot2_f32_bf16 v8, v38, s32, v8
    v_dot2_f32_bf16 v8, v39, s32, v8
    s_nop 2
    ds_add_f32 v6, v8 offset:37248
    s_waitcnt lgkmcnt(0)
    s_barrier
    v_cmp_gt_u32 vcc, 112, v0
    s_nop 3
    s_and_saveexec_b64 s[40:41], vcc
    s_cbranch_execz AB_wjr
    ds_read_b32 v8, v102 offset:36864
    ds_read_b32 v9, v102 offset:37376
    ds_read_b32 v10, v102 offset:37888
    ds_read_b32 v11, v102 offset:38400
    s_lshl_b32 s43, s51, 4
    s_add_u32 s43, s43, s50
    s_mul_i32 s43, s43, 448
    s_waitcnt lgkmcnt(0)
    v_add_f32 v8, v8, v9
    v_add_f32 v10, v10, v11
    v_add_f32 v8, v8, v10
    buffer_store_dword v8, v102, s[24:27], s43 offen sc1
AB_wjr:
    s_mov_b64 exec, s[40:41]
    s_branch AB_wjdone
AB_wjo:
    s_cmp_ge_u32 s2, 112
    s_cbranch_scc1 AB_wjdone
    v_mul_u32_u24 v5, 160, v5
    v_lshl_add_u32 v5, v6, 3, v5
    s_mul_i32 s42, s50, 28
    s_mul_i32 s43, s51, 7
    s_add_u32 s42, s42, s43
    s_mul_i32 s42, s42, 5120
    s_lshl_b32 s43, s3, 10
    s_add_u32 s42, s42, s43
    s_add_u32 s20, s6, 34865152
    s_addc_u32 s21, s7, 0
    s_mov_b32 s22, 1146880
    s_mov_b32 s23, 0x00020000
    s_add_u32 s52, s3, 0
    s_mul_i32 s53, s52, 52
    s_lshr_b32 s53, s53, 8
    s_mul_i32 s54, s53, 5
    s_sub_u32 s54, s52, s54
    s_lshl_b32 s55, s53, 5
    s_cmp_ge_u32 s53, 3
    s_cselect_b32 s56, 16, 0
    s_add_u32 s55, s55, s56
    s_add_u32 s56, s55, 16
    s_cmp_eq_u32 s53, 6
    s_cselect_b32 s55, 96, s55
    s_cselect_b32 s56, 208, s56
    s_mul_i32 s55, s55, 160
    s_mul_i32 s56, s56, 160
    s_lshl_b32 s54, s54, 5
    s_add_u32 s55, s55, s54
    s_add_u32 s56, s56, s54
    v_add_u32 v8, s55, v5
    v_add_u32 v9, s56, v5
    ds_read_b64_tr_b16 v[12:13], v8
    ds_read_b64_tr_b16 v[14:15], v9
    s_add_u32 s52, s3, 4
    s_mul_i32 s53, s52, 52
    s_lshr_b32 s53, s53, 8
    s_mul_i32 s54, s53, 5
    s_sub_u32 s54, s52, s54
    s_lshl_b32 s55, s53, 5
    s_cmp_ge_u32 s53, 3
    s_cselect_b32 s56, 16, 0
    s_add_u32 s55, s55, s56
    s_add_u32 s56, s55, 16
    s_cmp_eq_u32 s53, 6
    s_cselect_b32 s55, 96, s55
    s_cselect_b32 s56, 208, s56
    s_mul_i32 s55, s55, 160
    s_mul_i32 s56, s56, 160
    s_lshl_b32 s54, s54, 5
    s_add_u32 s55, s55, s54
    s_add_u32 s56, s56, s54
    v_add_u32 v8, s55, v5
    v_add_u32 v9, s56, v5
    ds_read_b64_tr_b16 v[16:17], v8
    ds_read_b64_tr_b16 v[18:19], v9
    s_add_u32 s52, s3, 8
    s_mul_i32 s53, s52, 52
    s_lshr_b32 s53, s53, 8
    s_mul_i32 s54, s53, 5
    s_sub_u32 s54, s52, s54
    s_lshl_b32 s55, s53, 5
    s_cmp_ge_u32 s53, 3
    s_cselect_b32 s56, 16, 0
    s_add_u32 s55, s55, s56
    s_add_u32 s56, s55, 16
    s_cmp_eq_u32 s53, 6
    s_cselect_b32 s55, 96, s55
    s_cselect_b32 s56, 208, s56
    s_mul_i32 s55, s55, 160
    s_mul_i32 s56, s56, 160
    s_lshl_b32 s54, s54, 5
    s_add_u32 s55, s55, s54
    s_add_u32 s56, s56, s54
    v_add_u32 v8, s55, v5
    v_add_u32 v9, s56, v5
    ds_read_b64_tr_b16 v[20:21], v8
    ds_read_b64_tr_b16 v[22:23], v9
    s_add_u32 s52, s3, 12
    s_mul_i32 s53, s52, 52
    s_lshr_b32 s53, s53, 8
    s_mul_i32 s54, s53, 5
    s_sub_u32 s54, s52, s54
    s_lshl_b32 s55, s53, 5
    s_cmp_ge_u32 s53, 3
    s_cselect_b32 s56, 16, 0
    s_add_u32 s55, s55, s56
    s_add_u32 s56, s55, 16
    s_cmp_eq_u32 s53, 6
    s_cselect_b32 s55, 96, s55
    s_cselect_b32 s56, 208, s56
    s_mul_i32 s55, s55, 160
    s_mul_i32 s56, s56, 160
    s_lshl_b32 s54, s54, 5
    s_add_u32 s55, s55, s54
    s_add_u32 s56, s56, s54
    v_add_u32 v8, s55, v5
    v_add_u32 v9, s56, v5
    ds_read_b64_tr_b16 v[24:25], v8
    ds_read_b64_tr_b16 v[26:27], v9
    s_add_u32 s52, s3, 16
    s_mul_i32 s53, s52, 52
    s_lshr_b32 s53, s53, 8
    s_mul_i32 s54, s53, 5
    s_sub_u32 s54, s52, s54
    s_lshl_b32 s55, s53, 5
    s_cmp_ge_u32 s53, 3
    s_cselect_b32 s56, 16, 0
    s_add_u32 s55, s55, s56
    s_add_u32 s56, s55, 16
    s_cmp_eq_u32 s53, 6
    s_cselect_b32 s55, 96, s55
    s_cselect_b32 s56, 208, s56
    s_mul_i32 s55, s55, 160
    s_mul_i32 s56, s56, 160
    s_lshl_b32 s54, s54, 5
    s_add_u32 s55, s55, s54
    s_add_u32 s56, s56, s54
    v_add_u32 v8, s55, v5
    v_add_u32 v9, s56, v5
    ds_read_b64_tr_b16 v[28:29], v8
    ds_read_b64_tr_b16 v[30:31], v9
    s_add_u32 s52, s3, 20
    s_mul_i32 s53, s52, 52
    s_lshr_b32 s53, s53, 8
    s_mul_i32 s54, s53, 5
    s_sub_u32 s54, s52, s54
    s_lshl_b32 s55, s53, 5
    s_cmp_ge_u32 s53, 3
    s_cselect_b32 s56, 16, 0
    s_add_u32 s55, s55, s56
    s_add_u32 s56, s55, 16
    s_cmp_eq_u32 s53, 6
    s_cselect_b32 s55, 96, s55
    s_cselect_b32 s56, 208, s56
    s_mul_i32 s55, s55, 160
    s_mul_i32 s56, s56, 160
    s_lshl_b32 s54, s54, 5
    s_add_u32 s55, s55, s54
    s_add_u32 s56, s56, s54
    v_add_u32 v8, s55, v5
    v_add_u32 v9, s56, v5
    ds_read_b64_tr_b16 v[32:33], v8
    ds_read_b64_tr_b16 v[34:35], v9
    s_add_u32 s52, s3, 24
    s_mul_i32 s53, s52, 52
    s_lshr_b32 s53, s53, 8
    s_mul_i32 s54, s53, 5
    s_sub_u32 s54, s52, s54
    s_lshl_b32 s55, s53, 5
    s_cmp_ge_u32 s53, 3
    s_cselect_b32 s56, 16, 0
    s_add_u32 s55, s55, s56
    s_add_u32 s56, s55, 16
    s_cmp_eq_u32 s53, 6
    s_cselect_b32 s55, 96, s55
    s_cselect_b32 s56, 208, s56
    s_mul_i32 s55, s55, 160
    s_mul_i32 s56, s56, 160
    s_lshl_b32 s54, s54, 5
    s_add_u32 s55, s55, s54
    s_add_u32 s56, s56, s54
    v_add_u32 v8, s55, v5
    v_add_u32 v9, s56, v5
    ds_read_b64_tr_b16 v[36:37], v8
    ds_read_b64_tr_b16 v[38:39], v9
    s_add_u32 s52, s3, 28
    s_mul_i32 s53, s52, 52
    s_lshr_b32 s53, s53, 8
    s_mul_i32 s54, s53, 5
    s_sub_u32 s54, s52, s54
    s_lshl_b32 s55, s53, 5
    s_cmp_ge_u32 s53, 3
    s_cselect_b32 s56, 16, 0
    s_add_u32 s55, s55, s56
    s_add_u32 s56, s55, 16
    s_cmp_eq_u32 s53, 6
    s_cselect_b32 s55, 96, s55
    s_cselect_b32 s56, 208, s56
    s_mul_i32 s55, s55, 160
    s_mul_i32 s56, s56, 160
    s_lshl_b32 s54, s54, 5
    s_add_u32 s55, s55, s54
    s_add_u32 s56, s56, s54
    v_add_u32 v8, s55, v5
    v_add_u32 v9, s56, v5
    ds_read_b64_tr_b16 v[40:41], v8
    ds_read_b64_tr_b16 v[42:43], v9
    s_add_u32 s52, s3, 32
    s_mul_i32 s53, s52, 52
    s_lshr_b32 s53, s53, 8
    s_mul_i32 s54, s53, 5
    s_sub_u32 s54, s52, s54
    s_lshl_b32 s55, s53, 5
    s_cmp_ge_u32 s53, 3
    s_cselect_b32 s56, 16, 0
    s_add_u32 s55, s55, s56
    s_add_u32 s56, s55, 16
    s_cmp_eq_u32 s53, 6
    s_cselect_b32 s55, 96, s55
    s_cselect_b32 s56, 208, s56
    s_mul_i32 s55, s55, 160
    s_mul_i32 s56, s56, 160
    s_lshl_b32 s54, s54, 5
    s_add_u32 s55, s55, s54
    s_add_u32 s56, s56, s54
    v_add_u32 v8, s55, v5
    v_add_u32 v9, s56, v5
    s_cmp_eq_u32 s3, 3
    s_cbranch_scc1 AB_wjo2
    ds_read_b64_tr_b16 v[44:45], v8
    ds_read_b64_tr_b16 v[46:47], v9
AB_wjo2:
    s_waitcnt lgkmcnt(0)
    buffer_store_dwordx4 v[12:15], v7, s[20:23], s42 offen sc1
    s_add_u32 s42, s42, 4096
    s_waitcnt vmcnt(1)
    buffer_store_dwordx4 v[16:19], v7, s[20:23], s42 offen sc1
    s_add_u32 s42, s42, 4096
    s_waitcnt vmcnt(1)
    buffer_store_dwordx4 v[20:23], v7, s[20:23], s42 offen sc1
    s_add_u32 s42, s42, 4096
    s_waitcnt vmcnt(1)
    buffer_store_dwordx4 v[24:27], v7, s[20:23], s42 offen sc1
    s_add_u32 s42, s42, 4096
    s_waitcnt vmcnt(1)
    buffer_store_dwordx4 v[28:31], v7, s[20:23], s42 offen sc1
    s_add_u32 s42, s42, 4096
    s_waitcnt vmcnt(1)
    buffer_store_dwordx4 v[32:35], v7, s[20:23], s42 offen sc1
    s_add_u32 s42, s42, 4096
    s_waitcnt vmcnt(1)
    buffer_store_dwordx4 v[36:39], v7, s[20:23], s42 offen sc1
    s_add_u32 s42, s42, 4096
    s_waitcnt vmcnt(1)
    buffer_store_dwordx4 v[40:43], v7, s[20:23], s42 offen sc1
    s_add_u32 s42, s42, 4096
    s_waitcnt vmcnt(1)
    s_cmp_eq_u32 s3, 3
    s_cbranch_scc1 AB_wjdone
    buffer_store_dwordx4 v[44:47], v7, s[20:23], s42 offen sc1
    s_add_u32 s42, s42, 4096
    s_waitcnt vmcnt(1)
AB_wjdone:
AB_lnfin:
    s_endpgm
AB_notln:
    s_load_dwordx4 s[8:11], s[0:1], 8
    s_load_dwordx4 s[12:15], s[0:1], 24
    s_load_dwordx4 s[16:19], s[0:1], 40
    s_load_dwordx2 s[20:21], s[0:1], 72
    s_getpc_b64 s[22:23]
AB_pc:
    s_add_u32 s22, s22, AB_gtab-AB_pc
    s_addc_u32 s23, s23, 0
    v_mul_u32_u24 v29, 48, v0
    s_sub_u32 s46, s2, 128
    s_and_b32 s47, s46, 7
    s_mul_i32 s47, s47, 80
    s_lshr_b32 s46, s46, 3
    s_add_u32 s46, s46, s47
    v_and_b32 v5, 127, v0
    s_lshl_b32 s47, s46, 8
    v_lshl_add_u32 v6, v5, 1, s47
    s_lshl_b32 s48, s46, 1
    s_and_b32 s49, s48, 0xfffffffc
    s_waitcnt lgkmcnt(0)
    global_load_ushort v10, v6, s[8:9]
    global_load_ushort v11, v6, s[10:11]
    global_load_ushort v12, v6, s[12:13]
    global_load_ushort v13, v6, s[14:15]
    s_load_dword s24, s[16:17], s49
    s_load_dword s25, s[18:19], s49
    global_load_dwordx4 v[60:63], v29, s[22:23]
    global_load_dwordx4 v[64:67], v29, s[22:23] offset:16
    global_load_dwordx4 v[68:71], v29, s[22:23] offset:32
    s_cmp_lg_u32 s3, 1
    s_cbranch_scc1 AB_nocp
    s_getpc_b64 s[40:41]
ABcp_pc:
    s_sub_u32 s40, s40, ABcp_pc-prep_kernel
    s_subb_u32 s41, s41, 0
    s_bfe_u32 s42, s2, 0x50003
    s_lshl_b32 s42, s42, 10
    s_cmp_ge_u32 s42, AB_gtab-prep_kernel
    s_cbranch_scc1 ABcp_skip
    v_lshl_add_u32 v14, v1, 4, s42
    global_load_dwordx4 v[120:123], v14, s[40:41]
ABcp_skip:
AB_nocp:
    v_mov_b32 v20, 0
    v_mov_b32 v21, 0
    v_mov_b32 v22, 0
    v_mov_b32 v23, 0
    v_lshlrev_b32 v24, 4, v0
    v_cmp_gt_u32 vcc, 32, v0
    s_nop 3
    s_and_saveexec_b64 s[36:37], vcc
    ds_write_b128 v24, v[20:23] offset:42560
    v_lshrrev_b32 v25, 1, v0
    v_mul_u32_u24 v25, 4160, v25
    v_and_b32 v26, 1, v0
    v_lshl_add_u32 v25, v26, 4, v25
    v_cmp_gt_u32 vcc, 8, v0
    s_nop 3
    s_and_b64 exec, exec, vcc
    ds_write_b128 v25, v[20:23] offset:28672
    ds_write_b32 v20, v20 offset:42500
    s_mov_b64 exec, s[36:37]
    v_lshlrev_b32 v31, 5, v2
    v_lshl_add_u32 v31, v4, 2, v31
    v_mul_u32_u24 v31, 48, v31
    v_cmp_gt_u32 vcc, 8, v3
    v_mov_b32 v32, 8
    v_mov_b32 v33, 32
    v_cndmask_b32 v32, v32, v33, vcc
    v_add_u32 v32, v31, v32
    v_cvt_f32_u32 v34, v3
    v_mul_u32_u24 v35, 48, v5
    v_lshrrev_b32 v36, 7, v0
    v_lshl_add_u32 v37, v36, 3, v35
    v_xor_b32 v38, 1, v36
    v_lshl_add_u32 v38, v38, 3, v35
    v_mul_u32_u24 v39, 768, v36
    v_add_u32 v39, 256, v39
    v_cvt_f32_u32 v39, v39
    v_lshrrev_b32 v7, 1, v0
    v_mul_u32_u24 v7, 20480, v7
    v_and_b32 v8, 1, v0
    v_lshl_add_u32 v7, v8, 4, v7
    s_and_b32 s26, s2, 63
    s_lshl_b32 s26, s26, 7
    s_add_u32 s26, s26, 34832384
    v_mov_b32 v8, s26
    global_load_dword v101, v8, s[6:7] sc1
    s_lshl_b32 s50, s46, 5
    v_lshrrev_b32 v9, 1, v0
    v_lshlrev_b32 v9, 7, v9
    v_and_b32 v25, 1, v0
    v_lshl_add_u32 v9, v25, 5, v9
    s_mov_b32 s59, 0
    s_waitcnt lgkmcnt(0)
    s_and_b32 s48, s48, 2
    s_lshl_b32 s48, s48, 3
    s_lshr_b32 s24, s24, s48
    s_lshl_b32 s24, s24, 16
    s_lshr_b32 s25, s25, s48
    s_and_b32 s25, s25, 0xffff
    v_mov_b32 v40, s24
    v_mul_f32 v40, 0x3fb8aa3b, v40
    v_exp_f32 v40, v40
    s_add_u32 s28, s6, 22478848
    s_addc_u32 s29, s7, 0
    s_mov_b32 s30, 2621440
    s_mov_b32 s31, 0x00020000
    v_cvt_pk_bf16_f32 v40, v40, v40
    v_lshlrev_b32 v40, 16, v40
    s_waitcnt vmcnt(4)
    s_mov_b32 s27, 0
    v_lshlrev_b32 v10, 16, v10
    v_lshlrev_b32 v11, 16, v11
    v_lshlrev_b32 v12, 16, v12
    v_lshlrev_b32 v13, 16, v13
    v_mul_f32 v10, 0x3fb8aa3b, v10
    v_exp_f32 v10, v10
    v_mul_f32 v11, v11, v40
    v_mul_f32 v45, 0x3e22f983, v11
    v_rndne_f32 v11, v45
    v_sub_f32 v45, v45, v11
    v_cvt_pk_bf16_f32 v10, v10, v10
    v_lshlrev_b32 v10, 16, v10
    v_mul_f32 v10, v10, v40
    v_mul_f32 v44, 0xbfb8aa3b, v10
    v_mul_f32 v12, v12, v40
    v_mul_f32 v13, v13, v40
    v_add_f32 v46, v12, v12
    v_add_f32 v47, v13, v13
    v_mul_f32 v48, v44, v39
    v_mul_f32 v49, v45, v39
    v_exp_f32 v48, v48
    v_fract_f32 v49, v49
    v_cos_f32 v50, v49
    v_sin_f32 v51, v49
    ds_write_b128 v35, v[44:47] offset:0
    v_pk_mul_f32 v[50:51], v[50:51], v[48:49] op_sel:[0,0] op_sel_hi:[1,0]
    v_pk_mul_f32 v[52:53], v[50:51], v[46:47] op_sel:[0,0] op_sel_hi:[1,0]
    v_pk_fma_f32 v[52:53], v[50:51], v[46:47], v[52:53] op_sel:[1,1,0] op_sel_hi:[0,1,1] neg_lo:[0,1,0]
    v_pk_mul_f32 v[54:55], v[50:51], v[52:53] op_sel:[0,0] op_sel_hi:[1,0]
    v_pk_fma_f32 v[54:55], v[50:51], v[52:53], v[54:55] op_sel:[1,1,0] op_sel_hi:[0,1,1] neg_lo:[0,1,0]
    ds_write_b64 v37, v[52:53] offset:16
    ds_write_b64 v38, v[54:55] offset:32
    s_waitcnt lgkmcnt(0)
    s_barrier
    v_mov_b32 v40, 0
    v_mov_b32 v41, 0
    v_mov_b32 v42, 0
    v_mov_b32 v43, 0
    v_mov_b32 v44, 0
    v_mov_b32 v45, 0
    v_mov_b32 v46, 0
    v_mov_b32 v47, 0
    v_mov_b32 v48, 0
    v_mov_b32 v49, 0
    v_mov_b32 v50, 0
    v_mov_b32 v51, 0
    v_mov_b32 v52, 0
    v_mov_b32 v53, 0
    v_mov_b32 v54, 0
    v_mov_b32 v55, 0
    s_mov_b32 s39, 0
    s_setprio 2
AB_kloop:
    ds_read_b128 v[72:75], v31 offset:0
    ds_read_b128 v[76:79], v31 offset:48
    ds_read_b128 v[80:83], v31 offset:96
    ds_read_b128 v[84:87], v31 offset:144
    ds_read_b128 v[88:91], v31 offset:16
    ds_read_b64 v[128:129], v32 offset:0
    ds_read_b128 v[92:95], v31 offset:64
    ds_read_b64 v[130:131], v32 offset:48
    ds_read_b128 v[96:99], v31 offset:112
    ds_read_b64 v[132:133], v32 offset:96
    ds_read_b128 v[124:127], v31 offset:160
    ds_read_b64 v[134:135], v32 offset:144
    v_add_u32 v31, 768, v31
    v_add_u32 v32, 768, v32
    s_waitcnt lgkmcnt(11)
    v_pk_mul_f32 v[18:19], v[72:73], v[34:35] op_sel:[0,0] op_sel_hi:[1,0]
    s_waitcnt lgkmcnt(10)
    v_pk_mul_f32 v[20:21], v[76:77], v[34:35] op_sel:[0,0] op_sel_hi:[1,0]
    s_waitcnt lgkmcnt(9)
    v_pk_mul_f32 v[22:23], v[80:81], v[34:35] op_sel:[0,0] op_sel_hi:[1,0]
    s_waitcnt lgkmcnt(8)
    v_pk_mul_f32 v[26:27], v[84:85], v[34:35] op_sel:[0,0] op_sel_hi:[1,0]
    v_exp_f32 v18, v18
    v_exp_f32 v20, v20
    v_exp_f32 v22, v22
    v_exp_f32 v26, v26
    v_cos_f32 v10, v19
    v_cos_f32 v12, v21
    v_cos_f32 v14, v23
    v_cos_f32 v16, v27
    v_sin_f32 v11, v19
    v_sin_f32 v13, v21
    v_sin_f32 v15, v23
    v_sin_f32 v17, v27
    v_pk_mul_f32 v[10:11], v[10:11], v[18:19] op_sel:[0,0] op_sel_hi:[1,0]
    v_pk_mul_f32 v[12:13], v[12:13], v[20:21] op_sel:[0,0] op_sel_hi:[1,0]
    v_pk_mul_f32 v[14:15], v[14:15], v[22:23] op_sel:[0,0] op_sel_hi:[1,0]
    v_pk_mul_f32 v[16:17], v[16:17], v[26:27] op_sel:[0,0] op_sel_hi:[1,0]
    v_cvt_pk_bf16_f32 v136, v10, v11
    v_cvt_pk_bf16_f32 v137, v12, v13
    v_cvt_pk_bf16_f32 v138, v14, v15
    v_cvt_pk_bf16_f32 v139, v16, v17
    v_pk_mul_f32 v[18:19], v[10:11], v[10:11] op_sel:[0,0] op_sel_hi:[1,0]
    v_pk_mul_f32 v[20:21], v[12:13], v[12:13] op_sel:[0,0] op_sel_hi:[1,0]
    v_pk_mul_f32 v[22:23], v[14:15], v[14:15] op_sel:[0,0] op_sel_hi:[1,0]
    v_pk_mul_f32 v[26:27], v[16:17], v[16:17] op_sel:[0,0] op_sel_hi:[1,0]
    v_pk_fma_f32 v[10:11], v[10:11], v[10:11], v[18:19] op_sel:[1,1,0] op_sel_hi:[0,1,1] neg_lo:[0,1,0]
    v_pk_fma_f32 v[12:13], v[12:13], v[12:13], v[20:21] op_sel:[1,1,0] op_sel_hi:[0,1,1] neg_lo:[0,1,0]
    v_pk_fma_f32 v[14:15], v[14:15], v[14:15], v[22:23] op_sel:[1,1,0] op_sel_hi:[0,1,1] neg_lo:[0,1,0]
    v_pk_fma_f32 v[16:17], v[16:17], v[16:17], v[26:27] op_sel:[1,1,0] op_sel_hi:[0,1,1] neg_lo:[0,1,0]
    v_pk_mul_f32 v[18:19], v[10:11], v[10:11] op_sel:[0,0] op_sel_hi:[1,0]
    v_pk_mul_f32 v[20:21], v[12:13], v[12:13] op_sel:[0,0] op_sel_hi:[1,0]
    v_pk_mul_f32 v[22:23], v[14:15], v[14:15] op_sel:[0,0] op_sel_hi:[1,0]
    v_pk_mul_f32 v[26:27], v[16:17], v[16:17] op_sel:[0,0] op_sel_hi:[1,0]
    v_pk_fma_f32 v[10:11], v[10:11], v[10:11], v[18:19] op_sel:[1,1,0] op_sel_hi:[0,1,1] neg_lo:[0,1,0]
    v_pk_fma_f32 v[12:13], v[12:13], v[12:13], v[20:21] op_sel:[1,1,0] op_sel_hi:[0,1,1] neg_lo:[0,1,0]
    v_pk_fma_f32 v[14:15], v[14:15], v[14:15], v[22:23] op_sel:[1,1,0] op_sel_hi:[0,1,1] neg_lo:[0,1,0]
    v_pk_fma_f32 v[16:17], v[16:17], v[16:17], v[26:27] op_sel:[1,1,0] op_sel_hi:[0,1,1] neg_lo:[0,1,0]
    v_cvt_pk_bf16_f32 v140, v10, v11
    v_cvt_pk_bf16_f32 v141, v12, v13
    v_cvt_pk_bf16_f32 v142, v14, v15
    v_cvt_pk_bf16_f32 v143, v16, v17
    v_pk_mul_f32 v[18:19], v[10:11], v[10:11] op_sel:[0,0] op_sel_hi:[1,0]
    v_pk_mul_f32 v[20:21], v[12:13], v[12:13] op_sel:[0,0] op_sel_hi:[1,0]
    v_pk_mul_f32 v[22:23], v[14:15], v[14:15] op_sel:[0,0] op_sel_hi:[1,0]
    v_pk_mul_f32 v[26:27], v[16:17], v[16:17] op_sel:[0,0] op_sel_hi:[1,0]
    v_pk_fma_f32 v[10:11], v[10:11], v[10:11], v[18:19] op_sel:[1,1,0] op_sel_hi:[0,1,1] neg_lo:[0,1,0]
    v_pk_fma_f32 v[12:13], v[12:13], v[12:13], v[20:21] op_sel:[1,1,0] op_sel_hi:[0,1,1] neg_lo:[0,1,0]
    v_pk_fma_f32 v[14:15], v[14:15], v[14:15], v[22:23] op_sel:[1,1,0] op_sel_hi:[0,1,1] neg_lo:[0,1,0]
    v_pk_fma_f32 v[16:17], v[16:17], v[16:17], v[26:27] op_sel:[1,1,0] op_sel_hi:[0,1,1] neg_lo:[0,1,0]
    v_pk_mul_f32 v[18:19], v[10:11], v[10:11] op_sel:[0,0] op_sel_hi:[1,0]
    v_pk_mul_f32 v[20:21], v[12:13], v[12:13] op_sel:[0,0] op_sel_hi:[1,0]
    v_pk_mul_f32 v[22:23], v[14:15], v[14:15] op_sel:[0,0] op_sel_hi:[1,0]
    v_pk_mul_f32 v[26:27], v[16:17], v[16:17] op_sel:[0,0] op_sel_hi:[1,0]
    v_pk_fma_f32 v[10:11], v[10:11], v[10:11], v[18:19] op_sel:[1,1,0] op_sel_hi:[0,1,1] neg_lo:[0,1,0]
    v_pk_fma_f32 v[12:13], v[12:13], v[12:13], v[20:21] op_sel:[1,1,0] op_sel_hi:[0,1,1] neg_lo:[0,1,0]
    v_pk_fma_f32 v[14:15], v[14:15], v[14:15], v[22:23] op_sel:[1,1,0] op_sel_hi:[0,1,1] neg_lo:[0,1,0]
    v_pk_fma_f32 v[16:17], v[16:17], v[16:17], v[26:27] op_sel:[1,1,0] op_sel_hi:[0,1,1] neg_lo:[0,1,0]
    s_waitcnt lgkmcnt(0)
    global_load_dword v100, v8, s[6:7] sc1
    v_pk_mul_f32 v[18:19], v[10:11], v[74:75] op_sel:[0,0] op_sel_hi:[1,0]
    v_pk_mul_f32 v[20:21], v[12:13], v[78:79] op_sel:[0,0] op_sel_hi:[1,0]
    v_pk_mul_f32 v[22:23], v[14:15], v[82:83] op_sel:[0,0] op_sel_hi:[1,0]
    v_pk_mul_f32 v[26:27], v[16:17], v[86:87] op_sel:[0,0] op_sel_hi:[1,0]
    v_pk_fma_f32 v[18:19], v[10:11], v[74:75], v[18:19] op_sel:[1,1,0] op_sel_hi:[0,1,1] neg_lo:[0,1,0]
    v_pk_fma_f32 v[20:21], v[12:13], v[78:79], v[20:21] op_sel:[1,1,0] op_sel_hi:[0,1,1] neg_lo:[0,1,0]
    v_pk_fma_f32 v[22:23], v[14:15], v[82:83], v[22:23] op_sel:[1,1,0] op_sel_hi:[0,1,1] neg_lo:[0,1,0]
    v_pk_fma_f32 v[26:27], v[16:17], v[86:87], v[26:27] op_sel:[1,1,0] op_sel_hi:[0,1,1] neg_lo:[0,1,0]
    v_cvt_pk_bf16_f32 v144, v18, -v19
    v_cvt_pk_bf16_f32 v145, v20, -v21
    v_cvt_pk_bf16_f32 v146, v22, -v23
    v_cvt_pk_bf16_f32 v147, v26, -v27
    v_pk_mul_f32 v[18:19], v[10:11], v[88:89] op_sel:[0,0] op_sel_hi:[1,0]
    v_pk_mul_f32 v[20:21], v[12:13], v[92:93] op_sel:[0,0] op_sel_hi:[1,0]
    v_pk_mul_f32 v[22:23], v[14:15], v[96:97] op_sel:[0,0] op_sel_hi:[1,0]
    v_pk_mul_f32 v[26:27], v[16:17], v[124:125] op_sel:[0,0] op_sel_hi:[1,0]
    v_pk_fma_f32 v[18:19], v[10:11], v[88:89], v[18:19] op_sel:[1,1,0] op_sel_hi:[0,1,1] neg_lo:[0,1,0]
    v_pk_fma_f32 v[20:21], v[12:13], v[92:93], v[20:21] op_sel:[1,1,0] op_sel_hi:[0,1,1] neg_lo:[0,1,0]
    v_pk_fma_f32 v[22:23], v[14:15], v[96:97], v[22:23] op_sel:[1,1,0] op_sel_hi:[0,1,1] neg_lo:[0,1,0]
    v_pk_fma_f32 v[26:27], v[16:17], v[124:125], v[26:27] op_sel:[1,1,0] op_sel_hi:[0,1,1] neg_lo:[0,1,0]
    v_cvt_pk_bf16_f32 v148, v18, -v19
    v_cvt_pk_bf16_f32 v149, v20, -v21
    v_cvt_pk_bf16_f32 v150, v22, -v23
    v_cvt_pk_bf16_f32 v151, v26, -v27
    v_mfma_f32_16x16x32_bf16 v[40:43], v[136:139], v[144:147], v[40:43]
    v_pk_mul_f32 v[18:19], v[10:11], v[10:11] op_sel:[0,0] op_sel_hi:[1,0]
    v_pk_mul_f32 v[20:21], v[12:13], v[12:13] op_sel:[0,0] op_sel_hi:[1,0]
    v_pk_mul_f32 v[22:23], v[14:15], v[14:15] op_sel:[0,0] op_sel_hi:[1,0]
    v_pk_mul_f32 v[26:27], v[16:17], v[16:17] op_sel:[0,0] op_sel_hi:[1,0]
    v_pk_fma_f32 v[10:11], v[10:11], v[10:11], v[18:19] op_sel:[1,1,0] op_sel_hi:[0,1,1] neg_lo:[0,1,0]
    v_pk_fma_f32 v[12:13], v[12:13], v[12:13], v[20:21] op_sel:[1,1,0] op_sel_hi:[0,1,1] neg_lo:[0,1,0]
    v_pk_fma_f32 v[14:15], v[14:15], v[14:15], v[22:23] op_sel:[1,1,0] op_sel_hi:[0,1,1] neg_lo:[0,1,0]
    v_pk_fma_f32 v[16:17], v[16:17], v[16:17], v[26:27] op_sel:[1,1,0] op_sel_hi:[0,1,1] neg_lo:[0,1,0]
    v_pk_mul_f32 v[18:19], v[10:11], v[10:11] op_sel:[0,0] op_sel_hi:[1,0]
    v_pk_mul_f32 v[20:21], v[12:13], v[12:13] op_sel:[0,0] op_sel_hi:[1,0]
    v_pk_mul_f32 v[22:23], v[14:15], v[14:15] op_sel:[0,0] op_sel_hi:[1,0]
    v_pk_mul_f32 v[26:27], v[16:17], v[16:17] op_sel:[0,0] op_sel_hi:[1,0]
    v_pk_fma_f32 v[10:11], v[10:11], v[10:11], v[18:19] op_sel:[1,1,0] op_sel_hi:[0,1,1] neg_lo:[0,1,0]
    v_pk_fma_f32 v[12:13], v[12:13], v[12:13], v[20:21] op_sel:[1,1,0] op_sel_hi:[0,1,1] neg_lo:[0,1,0]
    v_pk_fma_f32 v[14:15], v[14:15], v[14:15], v[22:23] op_sel:[1,1,0] op_sel_hi:[0,1,1] neg_lo:[0,1,0]
    v_pk_fma_f32 v[16:17], v[16:17], v[16:17], v[26:27] op_sel:[1,1,0] op_sel_hi:[0,1,1] neg_lo:[0,1,0]
    v_mfma_f32_16x16x32_bf16 v[44:47], v[136:139], v[148:151], v[44:47]
    v_pk_mul_f32 v[18:19], v[10:11], v[128:129] op_sel:[0,0] op_sel_hi:[1,0]
    v_pk_mul_f32 v[20:21], v[12:13], v[130:131] op_sel:[0,0] op_sel_hi:[1,0]
    v_pk_mul_f32 v[22:23], v[14:15], v[132:133] op_sel:[0,0] op_sel_hi:[1,0]
    v_pk_mul_f32 v[26:27], v[16:17], v[134:135] op_sel:[0,0] op_sel_hi:[1,0]
    v_pk_fma_f32 v[18:19], v[10:11], v[128:129], v[18:19] op_sel:[1,1,0] op_sel_hi:[0,1,1] neg_lo:[0,1,0]
    v_pk_fma_f32 v[20:21], v[12:13], v[130:131], v[20:21] op_sel:[1,1,0] op_sel_hi:[0,1,1] neg_lo:[0,1,0]
    v_pk_fma_f32 v[22:23], v[14:15], v[132:133], v[22:23] op_sel:[1,1,0] op_sel_hi:[0,1,1] neg_lo:[0,1,0]
    v_pk_fma_f32 v[26:27], v[16:17], v[134:135], v[26:27] op_sel:[1,1,0] op_sel_hi:[0,1,1] neg_lo:[0,1,0]
    v_cvt_pk_bf16_f32 v152, v18, -v19
    v_cvt_pk_bf16_f32 v153, v20, -v21
    v_cvt_pk_bf16_f32 v154, v22, -v23
    v_cvt_pk_bf16_f32 v155, v26, -v27
    v_pk_mul_f32 v[18:19], v[10:11], v[90:91] op_sel:[0,0] op_sel_hi:[1,0]
    v_pk_mul_f32 v[20:21], v[12:13], v[94:95] op_sel:[0,0] op_sel_hi:[1,0]
    v_pk_mul_f32 v[22:23], v[14:15], v[98:99] op_sel:[0,0] op_sel_hi:[1,0]
    v_pk_mul_f32 v[26:27], v[16:17], v[126:127] op_sel:[0,0] op_sel_hi:[1,0]
    v_pk_fma_f32 v[18:19], v[10:11], v[90:91], v[18:19] op_sel:[1,1,0] op_sel_hi:[0,1,1] neg_lo:[0,1,0]
    v_pk_fma_f32 v[20:21], v[12:13], v[94:95], v[20:21] op_sel:[1,1,0] op_sel_hi:[0,1,1] neg_lo:[0,1,0]
    v_pk_fma_f32 v[22:23], v[14:15], v[98:99], v[22:23] op_sel:[1,1,0] op_sel_hi:[0,1,1] neg_lo:[0,1,0]
    v_pk_fma_f32 v[26:27], v[16:17], v[126:127], v[26:27] op_sel:[1,1,0] op_sel_hi:[0,1,1] neg_lo:[0,1,0]
    v_cvt_pk_bf16_f32 v156, v18, -v19
    v_cvt_pk_bf16_f32 v157, v20, -v21
    v_cvt_pk_bf16_f32 v158, v22, -v23
    v_cvt_pk_bf16_f32 v159, v26, -v27
    v_mfma_f32_16x16x32_bf16 v[48:51], v[140:143], v[152:155], v[48:51]
    s_nop 0
    v_mfma_f32_16x16x32_bf16 v[52:55], v[140:143], v[156:159], v[52:55]
    s_add_u32 s39, s39, 1
    s_cmp_lt_u32 s39, 2
    s_cbranch_scc1 AB_kloop
    v_lshlrev_b32 v10, 6, v3
    v_lshl_add_u32 v10, v4, 4, v10
    v_lshl_add_u32 v10, v2, 12, v10
    s_mov_b32 s52, 0x01010101
    s_setprio 3
    s_add_u32 s8, s6, 7864320
    s_addc_u32 s9, s7, 0
    s_mov_b32 s10, 16384
    s_mov_b32 s11, 0x00020000
    ds_write_b128 v10, v[40:43] offset:6144
    ds_write_b128 v10, v[44:47] offset:7168
    ds_write_b128 v10, v[48:51] offset:8192
    ds_write_b128 v10, v[52:55] offset:9216
    s_waitcnt vmcnt(1)
    v_add_u32 v28, 2, v101
    v_cmp_ne_u32 vcc, v100, v28
    s_nop 3
    s_cmp_eq_u64 vcc, 0
    s_cselect_b32 s59, 128, 0
    s_cbranch_scc0 AB_notyet
    buffer_load_dwordx4 v[100:103], v7, s[28:31], s50 offen sc1
    buffer_load_dwordx4 v[104:107], v9, s[8:11], 0 offen sc1
    buffer_load_dwordx4 v[108:111], v9, s[8:11], 0 offen offset:16 sc1
    buffer_load_dwordx4 v[112:115], v9, s[8:11], 0 offen offset:64 sc1
    buffer_load_dwordx4 v[116:119], v9, s[8:11], 0 offen offset:80 sc1
AB_notyet:
    s_waitcnt lgkmcnt(0)
    s_barrier
    ds_read_b128 v[40:43], v24 offset:6144
    ds_read_b128 v[44:47], v24 offset:10240
    ds_read_b128 v[48:51], v24 offset:14336
    ds_read_b128 v[52:55], v24 offset:18432
    v_mov_b32 v20, 0
    s_waitcnt lgkmcnt(2)
    v_pk_add_f32 v[40:41], v[40:41], v[44:45]
    v_pk_add_f32 v[42:43], v[42:43], v[46:47]
    s_waitcnt lgkmcnt(0)
    v_pk_add_f32 v[48:49], v[48:49], v[52:53]
    v_pk_add_f32 v[50:51], v[50:51], v[54:55]
    v_pk_add_f32 v[40:41], v[40:41], v[48:49]
    v_pk_add_f32 v[42:43], v[42:43], v[50:51]
    s_and_b32 s40, s3, 1
    s_cmp_eq_u32 s40, 1
    s_cbranch_scc1 AB_odd
    v_cvt_pk_bf16_f32 v44, v40, v41
    v_cvt_pk_bf16_f32 v45, v42, v43
    v_lshlrev_b32 v12, 3, v1
    s_lshl_b32 s41, s3, 8
    v_add_u32 v12, s41, v12
    s_cmp_eq_u32 s3, 0
    s_cselect_b32 s42, 0, 32
    v_cmp_le_u32 vcc, s42, v1
    s_nop 3
    s_and_saveexec_b64 s[36:37], vcc
    ds_write_b64 v12, v[44:45] offset:41216
    s_mov_b64 exec, 1
    s_cmp_eq_u32 s3, 0
    s_cbranch_scc1 AB_ev
    ds_write_b16 v20, v44 offset:42496
AB_ev:
    s_mov_b64 exec, s[36:37]
    s_branch AB_tabdone
AB_odd:
    v_cvt_pk_bf16_f32 v44, v40, v42
    v_lshlrev_b32 v12, 2, v1
    s_lshl_b32 s41, s3, 8
    s_add_u32 s41, s41, 256
    v_add_u32 v12, s41, v12
    ds_write_b32 v12, v44 offset:41216
AB_tabdone:
    s_cmp_eq_u32 s59, 128
    s_cbranch_scc1 AB_cp2
    s_waitcnt vmcnt(0)
    v_cmp_ne_u32 vcc, v100, v28
    s_nop 3
    s_cmp_eq_u64 vcc, 0
    s_cselect_b32 s59, 128, 0
    s_cbranch_scc0 AB_cp2b
    buffer_load_dwordx4 v[100:103], v7, s[28:31], s50 offen sc1
    buffer_load_dwordx4 v[104:107], v9, s[8:11], 0 offen sc1
    buffer_load_dwordx4 v[108:111], v9, s[8:11], 0 offen offset:16 sc1
    buffer_load_dwordx4 v[112:115], v9, s[8:11], 0 offen offset:64 sc1
    buffer_load_dwordx4 v[116:119], v9, s[8:11], 0 offen offset:80 sc1
    s_branch AB_cp2
AB_cp2b:
    global_load_dword v100, v8, s[6:7] sc1
AB_cp2:
    s_waitcnt lgkmcnt(0)
    s_barrier
    ds_read_u16 v72, v60
    ds_read_u16 v73, v61
    ds_read_u16 v74, v62
    ds_read_u16 v75, v63
    ds_read_u16 v76, v64
    ds_read_u16 v77, v65
    ds_read_u16 v78, v66
    ds_read_u16 v79, v67
    ds_read_u16 v80, v68
    ds_read_u16 v81, v69
    ds_read_u16 v82, v70
    v_sub_u32 v10, 3, v3
    v_and_b32 v10, 3, v10
    v_mul_u32_u24 v10, 4160, v10
    v_lshrrev_b32 v11, 2, v3
    v_lshlrev_b32 v11, 3, v11
    v_sub_u32 v10, v10, v11
    v_lshl_add_u32 v10, v4, 4, v10
    s_lshl_b32 s41, s3, 7
    s_sub_u32 s42, 24984, s41
    v_add_u32 v10, s42, v10
    v_lshlrev_b32 v11, 5, v3
    v_lshl_add_u32 v11, v4, 4, v11
    s_sub_u32 s42, 42976, s41
    v_add_u32 v11, s42, v11
    s_waitcnt lgkmcnt(0)
    v_lshl_or_b32 v40, v73, 16, v72
    v_lshl_or_b32 v41, v75, 16, v74
    v_lshl_or_b32 v42, v77, 16, v76
    v_lshl_or_b32 v43, v79, 16, v78
    ds_write_b128 v24, v[40:43] offset:24576
    v_lshl_or_b32 v44, v74, 16, v73
    v_lshl_or_b32 v45, v76, 16, v75
    v_lshl_or_b32 v46, v78, 16, v77
    v_lshl_or_b32 v47, v80, 16, v79
    ds_write_b128 v24, v[44:47] offset:28736
    v_lshl_or_b32 v48, v75, 16, v74
    v_lshl_or_b32 v49, v77, 16, v76
    v_lshl_or_b32 v50, v79, 16, v78
    v_lshl_or_b32 v51, v81, 16, v80
    ds_write_b128 v24, v[48:51] offset:32896
    v_lshl_or_b32 v52, v76, 16, v75
    v_lshl_or_b32 v53, v78, 16, v77
    v_lshl_or_b32 v54, v80, 16, v79
    v_lshl_or_b32 v55, v82, 16, v81
    ds_write_b128 v24, v[52:55] offset:37056
    s_waitcnt lgkmcnt(0)
    s_cmp_eq_u32 s59, 128
    s_cbranch_scc1 AB_ready
    s_waitcnt vmcnt(0)
    v_cmp_ne_u32 vcc, v100, v28
    s_nop 3
    s_cmp_eq_u64 vcc, 0
    s_cselect_b32 s59, 128, 0
    s_cbranch_scc0 AB_cp3
    buffer_load_dwordx4 v[100:103], v7, s[28:31], s50 offen sc1
    buffer_load_dwordx4 v[104:107], v9, s[8:11], 0 offen sc1
    buffer_load_dwordx4 v[108:111], v9, s[8:11], 0 offen offset:16 sc1
    buffer_load_dwordx4 v[112:115], v9, s[8:11], 0 offen offset:64 sc1
    buffer_load_dwordx4 v[116:119], v9, s[8:11], 0 offen offset:80 sc1
    s_branch AB_ready
AB_cp3:
    s_cmp_lg_u32 s3, 0
    s_cbranch_scc1 AB_ready
    v_mov_b32 v102, 0
AB_poll:
    global_load_dword v100, v8, s[6:7] sc1
    s_add_u32 s27, s27, 1
    s_and_b32 s53, s27, 7
    s_cbranch_scc1 AB_p1
    global_load_dword v101, v102, s[44:45] offset:8 sc1
    s_waitcnt vmcnt(0)
    v_readfirstlane_b32 s53, v101
    s_nop 3
    s_cmp_eq_u32 s53, 2
    s_cbranch_scc1 AB_ready
AB_p1:
    s_waitcnt vmcnt(0)
    v_cmp_ne_u32 vcc, v100, v28
    s_nop 3
    s_cbranch_vccz AB_ready
    s_sleep 3
    s_branch AB_poll
AB_ready:
    s_barrier
    s_cmp_eq_u32 s59, 128
    s_cbranch_scc1 AB_have
    buffer_load_dwordx4 v[100:103], v7, s[28:31], s50 offen sc1
    buffer_load_dwordx4 v[104:107], v9, s[8:11], 0 offen sc1
    buffer_load_dwordx4 v[108:111], v9, s[8:11], 0 offen offset:16 sc1
    buffer_load_dwordx4 v[112:115], v9, s[8:11], 0 offen offset:64 sc1
    buffer_load_dwordx4 v[116:119], v9, s[8:11], 0 offen offset:80 sc1
AB_have:
    ds_read_b64 v[44:45], v10 offset:3648
    ds_read_b64 v[46:47], v10 offset:3656
    ds_read_b64 v[48:49], v10 offset:3136
    ds_read_b64 v[50:51], v10 offset:3144
    ds_read_b64 v[52:53], v10 offset:2624
    ds_read_b64 v[54:55], v10 offset:2632
    ds_read_b64 v[56:57], v10 offset:2112
    ds_read_b64 v[58:59], v10 offset:2120
    ds_read_b64 v[60:61], v10 offset:1600
    ds_read_b64 v[62:63], v10 offset:1608
    ds_read_b64 v[64:65], v10 offset:1088
    ds_read_b64 v[66:67], v10 offset:1096
    ds_read_b64 v[68:69], v10 offset:576
    ds_read_b64 v[70:71], v10 offset:584
    ds_read_b64 v[72:73], v10 offset:64
    ds_read_b64 v[74:75], v10 offset:72
    ds_read_b64 v[124:125], v10 offset:3584
    ds_read_b64 v[126:127], v10 offset:3592
    ds_read_b64 v[128:129], v10 offset:3072
    ds_read_b64 v[130:131], v10 offset:3080
    ds_read_b64 v[132:133], v10 offset:2560
    ds_read_b64 v[134:135], v10 offset:2568
    ds_read_b64 v[136:137], v10 offset:2048
    ds_read_b64 v[138:139], v10 offset:2056
    ds_read_b64 v[140:141], v10 offset:1536
    ds_read_b64 v[142:143], v10 offset:1544
    ds_read_b64 v[144:145], v10 offset:1024
    ds_read_b64 v[146:147], v10 offset:1032
    ds_read_b64 v[148:149], v10 offset:512
    ds_read_b64 v[150:151], v10 offset:520
    ds_read_b64 v[152:153], v10 offset:0
    ds_read_b64 v[154:155], v10 offset:8
    s_waitcnt vmcnt(0)
    ds_write_b128 v24, v[100:103] offset:47232
    v_lshlrev_b32 v76, 16, v100
    v_and_b32 v77, 0xffff0000, v100
    v_lshlrev_b32 v78, 16, v101
    v_and_b32 v79, 0xffff0000, v101
    v_lshlrev_b32 v80, 16, v102
    v_and_b32 v81, 0xffff0000, v102
    v_lshlrev_b32 v82, 16, v103
    v_and_b32 v83, 0xffff0000, v103
    v_pk_add_f32 v[76:77], v[76:77], v[104:105] neg_lo:[0,1] neg_hi:[0,1]
    v_pk_add_f32 v[78:79], v[78:79], v[106:107] neg_lo:[0,1] neg_hi:[0,1]
    v_pk_add_f32 v[80:81], v[80:81], v[108:109] neg_lo:[0,1] neg_hi:[0,1]
    v_pk_add_f32 v[82:83], v[82:83], v[110:111] neg_lo:[0,1] neg_hi:[0,1]
    v_cvt_pk_bf16_f32 v84, v76, v77
    v_cvt_pk_bf16_f32 v85, v78, v79
    v_cvt_pk_bf16_f32 v86, v80, v81
    v_cvt_pk_bf16_f32 v87, v82, v83
    v_lshlrev_b32 v76, 16, v84
    v_and_b32 v77, 0xffff0000, v84
    v_lshlrev_b32 v78, 16, v85
    v_and_b32 v79, 0xffff0000, v85
    v_lshlrev_b32 v80, 16, v86
    v_and_b32 v81, 0xffff0000, v86
    v_lshlrev_b32 v82, 16, v87
    v_and_b32 v83, 0xffff0000, v87
    v_pk_mul_f32 v[76:77], v[76:77], v[112:113]
    v_pk_mul_f32 v[78:79], v[78:79], v[114:115]
    v_pk_mul_f32 v[80:81], v[80:81], v[116:117]
    v_pk_mul_f32 v[82:83], v[82:83], v[118:119]
    v_cvt_pk_bf16_f32 v84, v76, v77
    v_cvt_pk_bf16_f32 v85, v78, v79
    v_cvt_pk_bf16_f32 v86, v80, v81
    v_cvt_pk_bf16_f32 v87, v82, v83
    ds_write_b128 v24, v[84:87] offset:43072
    s_waitcnt lgkmcnt(0)
    s_barrier
    s_setprio 1
    ds_read_b128 v[76:79], v11 offset:64
    ds_read_b128 v[80:83], v11 offset:576
    ds_read_b128 v[84:87], v11 offset:1088
    ds_read_b128 v[88:91], v11 offset:1600
    ds_read_b128 v[92:95], v11 offset:2112
    ds_read_b128 v[96:99], v11 offset:2624
    ds_read_b128 v[100:103], v11 offset:3136
    ds_read_b128 v[104:107], v11 offset:3648
    ds_read_b128 v[108:111], v11 offset:0
    ds_read_b128 v[112:115], v11 offset:512
    ds_read_b128 v[116:119], v11 offset:1024
    ds_read_b128 v[156:159], v11 offset:1536
    ds_read_b128 v[160:163], v11 offset:2048
    ds_read_b128 v[164:167], v11 offset:2560
    s_waitcnt lgkmcnt(13)
    v_mfma_f32_16x16x32_bf16 v[12:15], v[44:47], v[76:79], 0
    v_mfma_f32_16x16x32_bf16 v[16:19], v[48:51], v[76:79], 0
    v_mfma_f32_16x16x32_bf16 v[20:23], v[52:55], v[76:79], 0
    v_mfma_f32_16x16x32_bf16 v[24:27], v[56:59], v[76:79], 0
    v_mfma_f32_16x16x32_bf16 v[28:31], v[60:63], v[76:79], 0
    v_mfma_f32_16x16x32_bf16 v[32:35], v[64:67], v[76:79], 0
    v_mfma_f32_16x16x32_bf16 v[36:39], v[68:71], v[76:79], 0
    v_mfma_f32_16x16x32_bf16 v[40:43], v[72:75], v[76:79], 0
    ds_read_b128 v[76:79], v11 offset:3072
    s_waitcnt lgkmcnt(13)
    v_mfma_f32_16x16x32_bf16 v[16:19], v[44:47], v[80:83], v[16:19]
    v_mfma_f32_16x16x32_bf16 v[20:23], v[48:51], v[80:83], v[20:23]
    v_mfma_f32_16x16x32_bf16 v[24:27], v[52:55], v[80:83], v[24:27]
    v_mfma_f32_16x16x32_bf16 v[28:31], v[56:59], v[80:83], v[28:31]
    v_mfma_f32_16x16x32_bf16 v[32:35], v[60:63], v[80:83], v[32:35]
    v_mfma_f32_16x16x32_bf16 v[36:39], v[64:67], v[80:83], v[36:39]
    v_mfma_f32_16x16x32_bf16 v[40:43], v[68:71], v[80:83], v[40:43]
    ds_read_b128 v[80:83], v11 offset:3584
    v_lshlrev_b32 v8, 4, v0
    s_cmp_lg_u32 s3, 1
    s_cbranch_scc1 AB_nocp2
    s_getpc_b64 s[40:41]
ABcp2_pc:
    s_add_u32 s40, s40, main_kernel-ABcp2_pc
    s_addc_u32 s41, s41, 0
    s_bfe_u32 s42, s2, 0x50003
    s_lshl_b32 s42, s42, 10
    s_cmp_ge_u32 s42, M_codeend-main_kernel
    s_cbranch_scc1 ABcp2_skip
    v_lshl_add_u32 v9, v1, 4, s42
    global_load_dwordx4 v[120:123], v9, s[40:41]
ABcp2_skip:
AB_nocp2:
    s_mov_b32 s32, s20
    s_mov_b32 s33, s21
    s_mov_b32 s34, 8388608
    s_mov_b32 s35, 0x00020000
    s_lshl_b32 s51, s46, 14
    s_cmp_ge_u32 s46, 512
    s_cbranch_scc1 AB_nopf
    buffer_load_dwordx4 v[120:123], v8, s[32:35], s51 offen
    s_add_u32 s51, s51, 4096
    buffer_load_dwordx4 v[120:123], v8, s[32:35], s51 offen
    s_add_u32 s51, s51, 4096
    buffer_load_dwordx4 v[120:123], v8, s[32:35], s51 offen
    s_add_u32 s51, s51, 4096
    buffer_load_dwordx4 v[120:123], v8, s[32:35], s51 offen
AB_nopf:
    s_waitcnt lgkmcnt(13)
    v_mfma_f32_16x16x32_bf16 v[20:23], v[44:47], v[84:87], v[20:23]
    v_mfma_f32_16x16x32_bf16 v[24:27], v[48:51], v[84:87], v[24:27]
    v_mfma_f32_16x16x32_bf16 v[28:31], v[52:55], v[84:87], v[28:31]
    v_mfma_f32_16x16x32_bf16 v[32:35], v[56:59], v[84:87], v[32:35]
    v_mfma_f32_16x16x32_bf16 v[36:39], v[60:63], v[84:87], v[36:39]
    v_mfma_f32_16x16x32_bf16 v[40:43], v[64:67], v[84:87], v[40:43]
    s_waitcnt lgkmcnt(12)
    v_mfma_f32_16x16x32_bf16 v[24:27], v[44:47], v[88:91], v[24:27]
    v_mfma_f32_16x16x32_bf16 v[28:31], v[48:51], v[88:91], v[28:31]
    v_mfma_f32_16x16x32_bf16 v[32:35], v[52:55], v[88:91], v[32:35]
    v_mfma_f32_16x16x32_bf16 v[36:39], v[56:59], v[88:91], v[36:39]
    v_mfma_f32_16x16x32_bf16 v[40:43], v[60:63], v[88:91], v[40:43]
    s_waitcnt lgkmcnt(11)
    v_mfma_f32_16x16x32_bf16 v[28:31], v[44:47], v[92:95], v[28:31]
    v_mfma_f32_16x16x32_bf16 v[32:35], v[48:51], v[92:95], v[32:35]
    v_mfma_f32_16x16x32_bf16 v[36:39], v[52:55], v[92:95], v[36:39]
    v_mfma_f32_16x16x32_bf16 v[40:43], v[56:59], v[92:95], v[40:43]
    s_waitcnt lgkmcnt(10)
    v_mfma_f32_16x16x32_bf16 v[32:35], v[44:47], v[96:99], v[32:35]
    v_mfma_f32_16x16x32_bf16 v[36:39], v[48:51], v[96:99], v[36:39]
    v_mfma_f32_16x16x32_bf16 v[40:43], v[52:55], v[96:99], v[40:43]
    s_waitcnt lgkmcnt(9)
    v_mfma_f32_16x16x32_bf16 v[36:39], v[44:47], v[100:103], v[36:39]
    v_mfma_f32_16x16x32_bf16 v[40:43], v[48:51], v[100:103], v[40:43]
    s_waitcnt lgkmcnt(8)
    v_mfma_f32_16x16x32_bf16 v[40:43], v[44:47], v[104:107], v[40:43]
    s_waitcnt lgkmcnt(0)
    v_mfma_f32_16x16x32_bf16 v[12:15], v[124:127], v[108:111], v[12:15]
    v_mfma_f32_16x16x32_bf16 v[16:19], v[128:131], v[108:111], v[16:19]
    v_mfma_f32_16x16x32_bf16 v[20:23], v[132:135], v[108:111], v[20:23]
    v_mfma_f32_16x16x32_bf16 v[24:27], v[136:139], v[108:111], v[24:27]
    v_mfma_f32_16x16x32_bf16 v[28:31], v[140:143], v[108:111], v[28:31]
    v_mfma_f32_16x16x32_bf16 v[32:35], v[144:147], v[108:111], v[32:35]
    v_mfma_f32_16x16x32_bf16 v[36:39], v[148:151], v[108:111], v[36:39]
    v_mfma_f32_16x16x32_bf16 v[40:43], v[152:155], v[108:111], v[40:43]
    v_mfma_f32_16x16x32_bf16 v[16:19], v[124:127], v[112:115], v[16:19]
    v_mfma_f32_16x16x32_bf16 v[20:23], v[128:131], v[112:115], v[20:23]
    v_mfma_f32_16x16x32_bf16 v[24:27], v[132:135], v[112:115], v[24:27]
    v_mfma_f32_16x16x32_bf16 v[28:31], v[136:139], v[112:115], v[28:31]
    v_mfma_f32_16x16x32_bf16 v[32:35], v[140:143], v[112:115], v[32:35]
    v_mfma_f32_16x16x32_bf16 v[36:39], v[144:147], v[112:115], v[36:39]
    v_mfma_f32_16x16x32_bf16 v[40:43], v[148:151], v[112:115], v[40:43]
    v_mfma_f32_16x16x32_bf16 v[20:23], v[124:127], v[116:119], v[20:23]
    v_mfma_f32_16x16x32_bf16 v[24:27], v[128:131], v[116:119], v[24:27]
    v_mfma_f32_16x16x32_bf16 v[28:31], v[132:135], v[116:119], v[28:31]
    v_mfma_f32_16x16x32_bf16 v[32:35], v[136:139], v[116:119], v[32:35]
    v_mfma_f32_16x16x32_bf16 v[36:39], v[140:143], v[116:119], v[36:39]
    v_mfma_f32_16x16x32_bf16 v[40:43], v[144:147], v[116:119], v[40:43]
    v_mfma_f32_16x16x32_bf16 v[24:27], v[124:127], v[156:159], v[24:27]
    v_mfma_f32_16x16x32_bf16 v[28:31], v[128:131], v[156:159], v[28:31]
    v_mfma_f32_16x16x32_bf16 v[32:35], v[132:135], v[156:159], v[32:35]
    v_mfma_f32_16x16x32_bf16 v[36:39], v[136:139], v[156:159], v[36:39]
    v_mfma_f32_16x16x32_bf16 v[40:43], v[140:143], v[156:159], v[40:43]
    v_mfma_f32_16x16x32_bf16 v[28:31], v[124:127], v[160:163], v[28:31]
    v_mfma_f32_16x16x32_bf16 v[32:35], v[128:131], v[160:163], v[32:35]
    v_mfma_f32_16x16x32_bf16 v[36:39], v[132:135], v[160:163], v[36:39]
    v_mfma_f32_16x16x32_bf16 v[40:43], v[136:139], v[160:163], v[40:43]
    v_mfma_f32_16x16x32_bf16 v[32:35], v[124:127], v[164:167], v[32:35]
    v_mfma_f32_16x16x32_bf16 v[36:39], v[128:131], v[164:167], v[36:39]
    v_mfma_f32_16x16x32_bf16 v[40:43], v[132:135], v[164:167], v[40:43]
    v_mfma_f32_16x16x32_bf16 v[36:39], v[124:127], v[76:79], v[36:39]
    v_mfma_f32_16x16x32_bf16 v[40:43], v[128:131], v[76:79], v[40:43]
    v_mfma_f32_16x16x32_bf16 v[40:43], v[124:127], v[80:83], v[40:43]
    s_setprio 1
    v_lshlrev_b32 v10, 4, v1
    v_lshl_add_u32 v11, v2, 10, v10
    v_lshl_add_u32 v10, v2, 13, v10
    s_barrier
    ds_write_b128 v11, v[12:15] offset:0
    ds_write_b128 v11, v[16:19] offset:4096
    ds_write_b128 v11, v[20:23] offset:8192
    ds_write_b128 v11, v[24:27] offset:12288
    ds_write_b128 v11, v[28:31] offset:16384
    ds_write_b128 v11, v[32:35] offset:20480
    ds_write_b128 v11, v[36:39] offset:24576
    ds_write_b128 v11, v[40:43] offset:28672
    v_lshlrev_b32 v44, 5, v3
    v_lshl_add_u32 v44, v4, 3, v44
    v_lshl_add_u32 v44, v2, 10, v44
    s_lshl_b32 s23, s46, 12
    v_add_u32 v45, s23, v44
    s_add_u32 s26, s6, 2621440
    s_addc_u32 s27, s7, 0
    s_lshl_b32 s54, s25, 16
    v_mov_b32 v46, s54
    s_mov_b32 s55, 0x3f803f80
    s_mov_b32 s56, 0x00003f80
    s_mov_b32 s57, 0x3f800000
    s_waitcnt lgkmcnt(0)
    s_barrier
    ds_read_b128 v[48:51], v10 offset:0
    ds_read_b128 v[52:55], v10 offset:1024
    ds_read_b128 v[56:59], v10 offset:2048
    ds_read_b128 v[60:63], v10 offset:3072
    ds_read_b64 v[80:81], v44 offset:43072
    ds_read_b64 v[82:83], v44 offset:47232
    ds_read_b128 v[64:67], v10 offset:4096
    ds_read_b128 v[68:71], v10 offset:5120
    ds_read_b128 v[72:75], v10 offset:6144
    ds_read_b128 v[76:79], v10 offset:7168
    ds_read_b64 v[84:85], v44 offset:43584
    ds_read_b64 v[86:87], v44 offset:47744
    s_waitcnt lgkmcnt(6)
    v_dot2_f32_bf16 v88, v80, s25, 0
    v_dot2_f32_bf16 v89, v80, s54, 0
    v_dot2_f32_bf16 v90, v81, s25, 0
    v_dot2_f32_bf16 v91, v81, s54, 0
    v_pk_add_f32 v[48:49], v[48:49], v[52:53]
    v_pk_add_f32 v[50:51], v[50:51], v[54:55]
    v_pk_add_f32 v[56:57], v[56:57], v[60:61]
    v_pk_add_f32 v[58:59], v[58:59], v[62:63]
    v_pk_add_f32 v[48:49], v[48:49], v[56:57]
    v_pk_add_f32 v[50:51], v[50:51], v[58:59]
    v_lshlrev_b32 v92, 16, v82
    v_and_b32 v93, 0xffff0000, v82
    v_lshlrev_b32 v94, 16, v83
    v_and_b32 v95, 0xffff0000, v83
    v_cvt_pk_bf16_f32 v52, v48, v88
    v_cvt_pk_bf16_f32 v53, v49, v89
    v_cvt_pk_bf16_f32 v54, v50, v90
    v_cvt_pk_bf16_f32 v55, v51, v91
    v_dot2_f32_bf16 v48, v52, s55, 0
    v_dot2_f32_bf16 v49, v53, s55, 0
    v_dot2_f32_bf16 v50, v54, s55, 0
    v_dot2_f32_bf16 v51, v55, s55, 0
    s_nop 0
    v_cvt_pk_bf16_f32 v52, v48, v49
    s_nop 0
    v_cvt_pk_bf16_f32 v53, v50, v51
    v_dot2_f32_bf16 v92, v52, s56, v92
    v_dot2_f32_bf16 v93, v52, s57, v93
    v_dot2_f32_bf16 v94, v53, s56, v94
    v_dot2_f32_bf16 v95, v53, s57, v95
    s_nop 0
    v_cvt_pk_bf16_f32 v56, v92, v93
    s_nop 0
    v_cvt_pk_bf16_f32 v57, v94, v95
    global_store_dwordx2 v45, v[56:57], s[26:27] offset:0 sc1
    s_waitcnt lgkmcnt(0)
    v_dot2_f32_bf16 v96, v84, s25, 0
    v_dot2_f32_bf16 v97, v84, s54, 0
    v_dot2_f32_bf16 v98, v85, s25, 0
    v_dot2_f32_bf16 v99, v85, s54, 0
    v_pk_add_f32 v[64:65], v[64:65], v[68:69]
    v_pk_add_f32 v[66:67], v[66:67], v[70:71]
    v_pk_add_f32 v[72:73], v[72:73], v[76:77]
    v_pk_add_f32 v[74:75], v[74:75], v[78:79]
    v_pk_add_f32 v[64:65], v[64:65], v[72:73]
    v_pk_add_f32 v[66:67], v[66:67], v[74:75]
    v_lshlrev_b32 v100, 16, v86
    v_and_b32 v101, 0xffff0000, v86
    v_lshlrev_b32 v102, 16, v87
    v_and_b32 v103, 0xffff0000, v87
    v_cvt_pk_bf16_f32 v68, v64, v96
    v_cvt_pk_bf16_f32 v69, v65, v97
    v_cvt_pk_bf16_f32 v70, v66, v98
    v_cvt_pk_bf16_f32 v71, v67, v99
    v_dot2_f32_bf16 v64, v68, s55, 0
    v_dot2_f32_bf16 v65, v69, s55, 0
    v_dot2_f32_bf16 v66, v70, s55, 0
    v_dot2_f32_bf16 v67, v71, s55, 0
    s_nop 0
    v_cvt_pk_bf16_f32 v68, v64, v65
    s_nop 0
    v_cvt_pk_bf16_f32 v69, v66, v67
    v_dot2_f32_bf16 v100, v68, s56, v100
    v_dot2_f32_bf16 v101, v68, s57, v101
    v_dot2_f32_bf16 v102, v69, s56, v102
    v_dot2_f32_bf16 v103, v69, s57, v103
    s_nop 0
    v_cvt_pk_bf16_f32 v72, v100, v101
    s_nop 0
    v_cvt_pk_bf16_f32 v73, v102, v103
    global_store_dwordx2 v45, v[72:73], s[26:27] offset:512 sc1
    s_endpgm
A_end:
    s_endpgm
.p2align 6
.type AB_gtab,@object
AB_gtab:
.long 42496, 42496, 42496, 42496, 42494, 42494, 42494, 42494, 42494, 42494, 42494, 42492
.long 42494, 42494, 42494, 42492, 42492, 42492, 42492, 42492, 42492, 42492, 42492, 42492
.long 42492, 42492, 42492, 42492, 42490, 42490, 42490, 42490, 42490, 42490, 42490, 42488
.long 42490, 42490, 42490, 42488, 42488, 42488, 42488, 42488, 42488, 42488, 42488, 42488
.long 42488, 42488, 42488, 42488, 42486, 42486, 42486, 42486, 42486, 42486, 42486, 42484
.long 42486, 42486, 42486, 42484, 42484, 42484, 42484, 42484, 42484, 42484, 42484, 42484
.long 42484, 42484, 42484, 42484, 42482, 42482, 42482, 42482, 42482, 42482, 42482, 42480
.long 42482, 42482, 42482, 42480, 42480, 42480, 42480, 42480, 42480, 42480, 42480, 42480
.long 42480, 42480, 42480, 42480, 42478, 42478, 42478, 42478, 42478, 42478, 42478, 42476
.long 42478, 42478, 42478, 42476, 42476, 42476, 42476, 42476, 42476, 42476, 42476, 42476
.long 42476, 42476, 42476, 42476, 42474, 42474, 42474, 42474, 42474, 42474, 42474, 42472
.long 42474, 42474, 42474, 42472, 42472, 42472, 42472, 42472, 42472, 42472, 42472, 42472
.long 42472, 42472, 42472, 42472, 42470, 42470, 42470, 42470, 42470, 42470, 42470, 42468
.long 42470, 42470, 42470, 42468, 42468, 42468, 42468, 42468, 42468, 42468, 42468, 42468
.long 42468, 42468, 42468, 42468, 42466, 42466, 42466, 42466, 42466, 42466, 42466, 42464
.long 42466, 42466, 42466, 42464, 42464, 42464, 42464, 42464, 42464, 42464, 42464, 42464
.long 42464, 42464, 42464, 42464, 42462, 42462, 42462, 42462, 42462, 42462, 42462, 42460
.long 42462, 42462, 42462, 42460, 42460, 42460, 42460, 42460, 42460, 42460, 42460, 42460
.long 42460, 42460, 42460, 42460, 42458, 42458, 42458, 42458, 42458, 42458, 42458, 42456
.long 42458, 42458, 42458, 42456, 42456, 42456, 42456, 42456, 42456, 42456, 42456, 42456
.long 42456, 42456, 42456, 42456, 42454, 42454, 42454, 42454, 42454, 42454, 42454, 42452
.long 42454, 42454, 42454, 42452, 42452, 42452, 42452, 42452, 42452, 42452, 42452, 42452
.long 42452, 42452, 42452, 42452, 42450, 42450, 42450, 42450, 42450, 42450, 42450, 42448
.long 42450, 42450, 42450, 42448, 42448, 42448, 42448, 42448, 42448, 42448, 42448, 42448
.long 42448, 42448, 42448, 42448, 42446, 42446, 42446, 42446, 42446, 42446, 42446, 42444
.long 42446, 42446, 42446, 42444, 42444, 42444, 42444, 42444, 42444, 42444, 42444, 42444
.long 42444, 42444, 42444, 42444, 42442, 42442, 42442, 42442, 42442, 42442, 42442, 42440
.long 42442, 42442, 42442, 42440, 42440, 42440, 42440, 42440, 42440, 42440, 42440, 42440
.long 42440, 42440, 42440, 42440, 42438, 42438, 42438, 42438, 42438, 42438, 42438, 42436
.long 42438, 42438, 42438, 42436, 42436, 42436, 42436, 42436, 42436, 42436, 42436, 42436
.long 42436, 42436, 42436, 42436, 42434, 42434, 42434, 42434, 42434, 42434, 42434, 42432
.long 42434, 42434, 42434, 42432, 42432, 42432, 42432, 42432, 42432, 42432, 42432, 42432
.long 42432, 42432, 42432, 42432, 42430, 42430, 42430, 42430, 42430, 42430, 42430, 42428
.long 42430, 42430, 42430, 42428, 42428, 42428, 42428, 42428, 42428, 42428, 42428, 42428
.long 42428, 42428, 42428, 42428, 42426, 42426, 42426, 42426, 42426, 42426, 42426, 42424
.long 42426, 42426, 42426, 42424, 42424, 42424, 42424, 42424, 42424, 42424, 42424, 42424
.long 42424, 42424, 42424, 42424, 42422, 42422, 42422, 42422, 42422, 42422, 42422, 42420
.long 42422, 42422, 42422, 42420, 42420, 42420, 42420, 42420, 42420, 42420, 42420, 42420
.long 42420, 42420, 42420, 42420, 42418, 42418, 42418, 42418, 42418, 42418, 42418, 42416
.long 42418, 42418, 42418, 42416, 42416, 42416, 42416, 42416, 42416, 42416, 42416, 42416
.long 42416, 42416, 42416, 42416, 42414, 42414, 42414, 42414, 42414, 42414, 42414, 42412
.long 42414, 42414, 42414, 42412, 42412, 42412, 42412, 42412, 42412, 42412, 42412, 42412
.long 42412, 42412, 42412, 42412, 42410, 42410, 42410, 42410, 42410, 42410, 42410, 42408
.long 42410, 42410, 42410, 42408, 42408, 42408, 42408, 42408, 42408, 42408, 42408, 42408
.long 42408, 42408, 42408, 42408, 42406, 42406, 42406, 42406, 42406, 42406, 42406, 42404
.long 42406, 42406, 42406, 42404, 42404, 42404, 42404, 42404, 42404, 42404, 42404, 42404
.long 42404, 42404, 42404, 42404, 42402, 42402, 42402, 42402, 42402, 42402, 42402, 42400
.long 42402, 42402, 42402, 42400, 42400, 42400, 42400, 42400, 42400, 42400, 42400, 42400
.long 42400, 42400, 42400, 42400, 42398, 42398, 42398, 42398, 42398, 42398, 42398, 42396
.long 42398, 42398, 42398, 42396, 42396, 42396, 42396, 42396, 42396, 42396, 42396, 42396
.long 42396, 42396, 42396, 42396, 42394, 42394, 42394, 42394, 42394, 42394, 42394, 42392
.long 42394, 42394, 42394, 42392, 42392, 42392, 42392, 42392, 42392, 42392, 42392, 42392
.long 42392, 42392, 42392, 42392, 42390, 42390, 42390, 42390, 42390, 42390, 42390, 42388
.long 42390, 42390, 42390, 42388, 42388, 42388, 42388, 42388, 42388, 42388, 42388, 42388
.long 42388, 42388, 42388, 42388, 42386, 42386, 42386, 42386, 42386, 42386, 42386, 42384
.long 42386, 42386, 42386, 42384, 42384, 42384, 42384, 42384, 42384, 42384, 42384, 42384
.long 42384, 42384, 42384, 42384, 42382, 42382, 42382, 42382, 42382, 42382, 42382, 42380
.long 42382, 42382, 42382, 42380, 42380, 42380, 42380, 42380, 42380, 42380, 42380, 42380
.long 42380, 42380, 42380, 42380, 42378, 42378, 42378, 42378, 42378, 42378, 42378, 42376
.long 42378, 42378, 42378, 42376, 42376, 42376, 42376, 42376, 42376, 42376, 42376, 42376
.long 42376, 42376, 42376, 42376, 42374, 42374, 42374, 42374, 42374, 42374, 42374, 42372
.long 42374, 42374, 42374, 42372, 42372, 42372, 42372, 42372, 42372, 42372, 42372, 42372
.long 42372, 42372, 42372, 42372, 42370, 42370, 42370, 42370, 42370, 42370, 42370, 42368
.long 42370, 42370, 42370, 42368, 42368, 42368, 42368, 42368, 42368, 42368, 42368, 42368
.long 42368, 42368, 42368, 42368, 42366, 42366, 42366, 42366, 42366, 42366, 42366, 42364
.long 42366, 42366, 42366, 42364, 42364, 42364, 42364, 42364, 42364, 42364, 42364, 42364
.long 42364, 42364, 42364, 42364, 42362, 42362, 42362, 42362, 42362, 42362, 42362, 42360
.long 42362, 42362, 42362, 42360, 42360, 42360, 42360, 42360, 42360, 42360, 42360, 42360
.long 42360, 42360, 42360, 42360, 42358, 42358, 42358, 42358, 42358, 42358, 42358, 42356
.long 42358, 42358, 42358, 42356, 42356, 42356, 42356, 42356, 42356, 42356, 42356, 42356
.long 42356, 42356, 42356, 42356, 42354, 42354, 42354, 42354, 42354, 42354, 42354, 42352
.long 42354, 42354, 42354, 42352, 42352, 42352, 42352, 42352, 42352, 42352, 42352, 42352
.long 42352, 42352, 42352, 42352, 42350, 42350, 42350, 42350, 42350, 42350, 42350, 42348
.long 42350, 42350, 42350, 42348, 42348, 42348, 42348, 42348, 42348, 42348, 42348, 42348
.long 42348, 42348, 42348, 42348, 42346, 42346, 42346, 42346, 42346, 42346, 42346, 42344
.long 42346, 42346, 42346, 42344, 42344, 42344, 42344, 42344, 42344, 42344, 42344, 42344
.long 42344, 42344, 42344, 42344, 42342, 42342, 42342, 42342, 42342, 42342, 42342, 42340
.long 42342, 42342, 42342, 42340, 42340, 42340, 42340, 42340, 42340, 42340, 42340, 42340
.long 42340, 42340, 42340, 42340, 42338, 42338, 42338, 42338, 42338, 42338, 42338, 42336
.long 42338, 42338, 42338, 42336, 42336, 42336, 42336, 42336, 42336, 42336, 42336, 42336
.long 42336, 42336, 42336, 42336, 42334, 42334, 42334, 42334, 42334, 42334, 42334, 42332
.long 42334, 42334, 42334, 42332, 42332, 42332, 42332, 42332, 42332, 42332, 42332, 42332
.long 42332, 42332, 42332, 42332, 42330, 42330, 42330, 42330, 42330, 42330, 42330, 42328
.long 42330, 42330, 42330, 42328, 42328, 42328, 42328, 42328, 42328, 42328, 42328, 42328
.long 42328, 42328, 42328, 42328, 42326, 42326, 42326, 42326, 42326, 42326, 42326, 42324
.long 42326, 42326, 42326, 42324, 42324, 42324, 42324, 42324, 42324, 42324, 42324, 42324
.long 42324, 42324, 42324, 42324, 42322, 42322, 42322, 42322, 42322, 42322, 42322, 42320
.long 42322, 42322, 42322, 42320, 42320, 42320, 42320, 42320, 42320, 42320, 42320, 42320
.long 42320, 42320, 42320, 42320, 42318, 42318, 42318, 42318, 42318, 42318, 42318, 42316
.long 42318, 42318, 42318, 42316, 42316, 42316, 42316, 42316, 42316, 42316, 42316, 42316
.long 42316, 42316, 42316, 42316, 42314, 42314, 42314, 42314, 42314, 42314, 42314, 42312
.long 42314, 42314, 42314, 42312, 42312, 42312, 42312, 42312, 42312, 42312, 42312, 42312
.long 42312, 42312, 42312, 42312, 42310, 42310, 42310, 42310, 42310, 42310, 42310, 42308
.long 42310, 42310, 42310, 42308, 42308, 42308, 42308, 42308, 42308, 42308, 42308, 42308
.long 42308, 42308, 42308, 42308, 42306, 42306, 42306, 42306, 42306, 42306, 42306, 42304
.long 42306, 42306, 42306, 42304, 42304, 42304, 42304, 42304, 42304, 42304, 42304, 42304
.long 42304, 42304, 42304, 42304, 42302, 42302, 42302, 42302, 42302, 42302, 42302, 42300
.long 42302, 42302, 42302, 42300, 42300, 42300, 42300, 42300, 42300, 42300, 42300, 42300
.long 42300, 42300, 42300, 42300, 42298, 42298, 42298, 42298, 42298, 42298, 42298, 42296
.long 42298, 42298, 42298, 42296, 42296, 42296, 42296, 42296, 42296, 42296, 42296, 42296
.long 42296, 42296, 42296, 42296, 42294, 42294, 42294, 42294, 42294, 42294, 42294, 42292
.long 42294, 42294, 42294, 42292, 42292, 42292, 42292, 42292, 42292, 42292, 42292, 42292
.long 42292, 42292, 42292, 42292, 42290, 42290, 42290, 42290, 42290, 42290, 42290, 42288
.long 42290, 42290, 42290, 42288, 42288, 42288, 42288, 42288, 42288, 42288, 42288, 42288
.long 42288, 42288, 42288, 42288, 42286, 42286, 42286, 42286, 42286, 42286, 42286, 42284
.long 42286, 42286, 42286, 42284, 42284, 42284, 42284, 42284, 42284, 42284, 42284, 42284
.long 42284, 42284, 42284, 42284, 42282, 42282, 42282, 42282, 42282, 42282, 42282, 42280
.long 42282, 42282, 42282, 42280, 42280, 42280, 42280, 42280, 42280, 42280, 42280, 42280
.long 42280, 42280, 42280, 42280, 42278, 42278, 42278, 42278, 42278, 42278, 42278, 42276
.long 42278, 42278, 42278, 42276, 42276, 42276, 42276, 42276, 42276, 42276, 42276, 42276
.long 42276, 42276, 42276, 42276, 42274, 42274, 42274, 42274, 42274, 42274, 42274, 42272
.long 42274, 42274, 42274, 42272, 42272, 42272, 42272, 42272, 42272, 42272, 42272, 42272
.long 42272, 42272, 42272, 42272, 42270, 42270, 42270, 42270, 42270, 42270, 42270, 42268
.long 42270, 42270, 42270, 42268, 42268, 42268, 42268, 42268, 42268, 42268, 42268, 42268
.long 42268, 42268, 42268, 42268, 42266, 42266, 42266, 42266, 42266, 42266, 42266, 42264
.long 42266, 42266, 42266, 42264, 42264, 42264, 42264, 42264, 42264, 42264, 42264, 42264
.long 42264, 42264, 42264, 42264, 42262, 42262, 42262, 42262, 42262, 42262, 42262, 42260
.long 42262, 42262, 42262, 42260, 42260, 42260, 42260, 42260, 42260, 42260, 42260, 42260
.long 42260, 42260, 42260, 42260, 42258, 42258, 42258, 42258, 42258, 42258, 42258, 42256
.long 42258, 42258, 42258, 42256, 42256, 42256, 42256, 42256, 42256, 42256, 42256, 42256
.long 42256, 42256, 42256, 42256, 42254, 42254, 42254, 42254, 42254, 42254, 42254, 42252
.long 42254, 42254, 42254, 42252, 42252, 42252, 42252, 42252, 42252, 42252, 42252, 42252
.long 42252, 42252, 42252, 42252, 42250, 42250, 42250, 42250, 42250, 42250, 42250, 42248
.long 42250, 42250, 42250, 42248, 42248, 42248, 42248, 42248, 42248, 42248, 42248, 42248
.long 42248, 42248, 42248, 42248, 42246, 42246, 42246, 42246, 42246, 42246, 42246, 42244
.long 42246, 42246, 42246, 42244, 42244, 42244, 42244, 42244, 42244, 42244, 42244, 42244
.long 42244, 42244, 42244, 42244, 42242, 42242, 42242, 42242, 42242, 42242, 42242, 42240
.long 42242, 42242, 42242, 42240, 42240, 42240, 42240, 42240, 42240, 42240, 42238, 42238
.long 42240, 42240, 42238, 42238, 42238, 42236, 42236, 42236, 42236, 42236, 42234, 42234
.long 42236, 42236, 42234, 42234, 42234, 42232, 42232, 42232, 42232, 42232, 42230, 42230
.long 42232, 42232, 42230, 42230, 42230, 42228, 42228, 42228, 42228, 42228, 42226, 42226
.long 42228, 42228, 42226, 42226, 42226, 42224, 42224, 42224, 42224, 42224, 42222, 42222
.long 42224, 42224, 42222, 42222, 42222, 42220, 42220, 42220, 42220, 42220, 42218, 42218
.long 42220, 42220, 42218, 42218, 42218, 42216, 42216, 42216, 42216, 42216, 42214, 42214
.long 42216, 42216, 42214, 42214, 42214, 42212, 42212, 42212, 42212, 42212, 42210, 42210
.long 42212, 42212, 42210, 42210, 42210, 42208, 42208, 42208, 42208, 42208, 42206, 42206
.long 42208, 42208, 42206, 42206, 42206, 42204, 42204, 42204, 42204, 42204, 42202, 42202
.long 42204, 42204, 42202, 42202, 42202, 42200, 42200, 42200, 42200, 42200, 42198, 42198
.long 42200, 42200, 42198, 42198, 42198, 42196, 42196, 42196, 42196, 42196, 42194, 42194
.long 42196, 42196, 42194, 42194, 42194, 42192, 42192, 42192, 42192, 42192, 42190, 42190
.long 42192, 42192, 42190, 42190, 42190, 42188, 42188, 42188, 42188, 42188, 42186, 42186
.long 42188, 42188, 42186, 42186, 42186, 42184, 42184, 42184, 42184, 42184, 42182, 42182
.long 42184, 42184, 42182, 42182, 42182, 42180, 42180, 42180, 42180, 42180, 42178, 42178
.long 42180, 42180, 42178, 42178, 42178, 42176, 42176, 42176, 42176, 42176, 42174, 42174
.long 42176, 42176, 42174, 42174, 42174, 42172, 42172, 42172, 42172, 42172, 42170, 42170
.long 42172, 42172, 42170, 42170, 42170, 42168, 42168, 42168, 42168, 42168, 42166, 42166
.long 42168, 42168, 42166, 42166, 42166, 42164, 42164, 42164, 42164, 42164, 42162, 42162
.long 42164, 42164, 42162, 42162, 42162, 42160, 42160, 42160, 42160, 42160, 42158, 42158
.long 42160, 42160, 42158, 42158, 42158, 42156, 42156, 42156, 42156, 42156, 42154, 42154
.long 42156, 42156, 42154, 42154, 42154, 42152, 42152, 42152, 42152, 42152, 42150, 42150
.long 42152, 42152, 42150, 42150, 42150, 42148, 42148, 42148, 42148, 42148, 42146, 42146
.long 42148, 42148, 42146, 42146, 42146, 42144, 42144, 42144, 42144, 42144, 42142, 42142
.long 42144, 42144, 42142, 42142, 42142, 42140, 42140, 42140, 42140, 42140, 42138, 42138
.long 42140, 42140, 42138, 42138, 42138, 42136, 42136, 42136, 42136, 42136, 42134, 42134
.long 42136, 42136, 42134, 42134, 42134, 42132, 42132, 42132, 42132, 42132, 42130, 42130
.long 42132, 42132, 42130, 42130, 42130, 42128, 42128, 42128, 42128, 42128, 42126, 42126
.long 42128, 42128, 42126, 42126, 42126, 42124, 42124, 42124, 42124, 42124, 42122, 42122
.long 42124, 42124, 42122, 42122, 42122, 42120, 42120, 42120, 42120, 42120, 42118, 42118
.long 42120, 42120, 42118, 42118, 42118, 42116, 42116, 42116, 42116, 42116, 42114, 42114
.long 42116, 42116, 42114, 42114, 42114, 42112, 42112, 42112, 42112, 42112, 42110, 42110
.long 42112, 42112, 42110, 42110, 42110, 42108, 42108, 42108, 42108, 42108, 42106, 42106
.long 42108, 42108, 42106, 42106, 42106, 42104, 42104, 42104, 42104, 42104, 42102, 42102
.long 42104, 42104, 42102, 42102, 42102, 42100, 42100, 42100, 42100, 42100, 42098, 42098
.long 42100, 42100, 42098, 42098, 42098, 42096, 42096, 42096, 42096, 42096, 42094, 42094
.long 42096, 42096, 42094, 42094, 42094, 42092, 42092, 42092, 42092, 42092, 42090, 42090
.long 42092, 42092, 42090, 42090, 42090, 42088, 42088, 42088, 42088, 42088, 42086, 42086
.long 42088, 42088, 42086, 42086, 42086, 42084, 42084, 42084, 42084, 42084, 42082, 42082
.long 42084, 42084, 42082, 42082, 42082, 42080, 42080, 42080, 42080, 42080, 42078, 42078
.long 42080, 42080, 42078, 42078, 42078, 42076, 42076, 42076, 42076, 42076, 42074, 42074
.long 42076, 42076, 42074, 42074, 42074, 42072, 42072, 42072, 42072, 42072, 42070, 42070
.long 42072, 42072, 42070, 42070, 42070, 42068, 42068, 42068, 42068, 42068, 42066, 42066
.long 42068, 42068, 42066, 42066, 42066, 42064, 42064, 42064, 42064, 42064, 42062, 42062
.long 42064, 42064, 42062, 42062, 42062, 42060, 42060, 42060, 42060, 42060, 42058, 42058
.long 42060, 42060, 42058, 42058, 42058, 42056, 42056, 42056, 42056, 42056, 42054, 42054
.long 42056, 42056, 42054, 42054, 42054, 42052, 42052, 42052, 42052, 42052, 42050, 42050
.long 42052, 42052, 42050, 42050, 42050, 42048, 42048, 42048, 42048, 42048, 42046, 42046
.long 42048, 42048, 42046, 42046, 42046, 42044, 42044, 42044, 42044, 42044, 42042, 42042
.long 42044, 42044, 42042, 42042, 42042, 42040, 42040, 42040, 42040, 42040, 42038, 42038
.long 42040, 42040, 42038, 42038, 42038, 42036, 42036, 42036, 42036, 42036, 42034, 42034
.long 42036, 42036, 42034, 42034, 42034, 42032, 42032, 42032, 42032, 42032, 42030, 42030
.long 42032, 42032, 42030, 42030, 42030, 42028, 42028, 42028, 42028, 42028, 42026, 42026
.long 42028, 42028, 42026, 42026, 42026, 42024, 42024, 42024, 42024, 42024, 42022, 42022
.long 42024, 42024, 42022, 42022, 42022, 42020, 42020, 42020, 42020, 42020, 42018, 42018
.long 42020, 42020, 42018, 42018, 42018, 42016, 42016, 42016, 42016, 42016, 42014, 42014
.long 42016, 42016, 42014, 42014, 42014, 42012, 42012, 42012, 42012, 42012, 42010, 42010
.long 42012, 42012, 42010, 42010, 42010, 42008, 42008, 42008, 42008, 42008, 42006, 42006
.long 42008, 42008, 42006, 42006, 42006, 42004, 42004, 42004, 42004, 42004, 42002, 42002
.long 42004, 42004, 42002, 42002, 42002, 42000, 42000, 42000, 42000, 42000, 41998, 41998
.long 42000, 42000, 41998, 41998, 41998, 41996, 41996, 41996, 41996, 41996, 41994, 41994
.long 41996, 41996, 41994, 41994, 41994, 41992, 41992, 41992, 41992, 41992, 41990, 41990
.long 41992, 41992, 41990, 41990, 41990, 41988, 41988, 41988, 41988, 41988, 41986, 41986
.long 41988, 41988, 41986, 41986, 41986, 41984, 41984, 41984, 41984, 41982, 41980, 41980
.long 41984, 41982, 41980, 41980, 41980, 41978, 41976, 41976, 41976, 41974, 41972, 41972
.long 41976, 41974, 41972, 41972, 41972, 41970, 41968, 41968, 41968, 41966, 41964, 41964
.long 41968, 41966, 41964, 41964, 41964, 41962, 41960, 41960, 41960, 41958, 41956, 41956
.long 41960, 41958, 41956, 41956, 41956, 41954, 41952, 41952, 41952, 41950, 41948, 41948
.long 41952, 41950, 41948, 41948, 41948, 41946, 41944, 41944, 41944, 41942, 41940, 41940
.long 41944, 41942, 41940, 41940, 41940, 41938, 41936, 41936, 41936, 41934, 41932, 41932
.long 41936, 41934, 41932, 41932, 41932, 41930, 41928, 41928, 41928, 41926, 41924, 41924
.long 41928, 41926, 41924, 41924, 41924, 41922, 41920, 41920, 41920, 41918, 41916, 41916
.long 41920, 41918, 41916, 41916, 41916, 41914, 41912, 41912, 41912, 41910, 41908, 41908
.long 41912, 41910, 41908, 41908, 41908, 41906, 41904, 41904, 41904, 41902, 41900, 41900
.long 41904, 41902, 41900, 41900, 41900, 41898, 41896, 41896, 41896, 41894, 41892, 41892
.long 41896, 41894, 41892, 41892, 41892, 41890, 41888, 41888, 41888, 41886, 41884, 41884
.long 41888, 41886, 41884, 41884, 41884, 41882, 41880, 41880, 41880, 41878, 41876, 41876
.long 41880, 41878, 41876, 41876, 41876, 41874, 41872, 41872, 41872, 41870, 41868, 41868
.long 41872, 41870, 41868, 41868, 41868, 41866, 41864, 41864, 41864, 41862, 41860, 41860
.long 41864, 41862, 41860, 41860, 41860, 41858, 41856, 41856, 41856, 41854, 41852, 41852
.long 41856, 41854, 41852, 41852, 41852, 41850, 41848, 41848, 41848, 41846, 41844, 41844
.long 41848, 41846, 41844, 41844, 41844, 41842, 41840, 41840, 41840, 41838, 41836, 41836
.long 41840, 41838, 41836, 41836, 41836, 41834, 41832, 41832, 41832, 41830, 41828, 41828
.long 41832, 41830, 41828, 41828, 41828, 41826, 41824, 41824, 41824, 41822, 41820, 41820
.long 41824, 41822, 41820, 41820, 41820, 41818, 41816, 41816, 41816, 41814, 41812, 41812
.long 41816, 41814, 41812, 41812, 41812, 41810, 41808, 41808, 41808, 41806, 41804, 41804
.long 41808, 41806, 41804, 41804, 41804, 41802, 41800, 41800, 41800, 41798, 41796, 41796
.long 41800, 41798, 41796, 41796, 41796, 41794, 41792, 41792, 41792, 41790, 41788, 41788
.long 41792, 41790, 41788, 41788, 41788, 41786, 41784, 41784, 41784, 41782, 41780, 41780
.long 41784, 41782, 41780, 41780, 41780, 41778, 41776, 41776, 41776, 41774, 41772, 41772
.long 41776, 41774, 41772, 41772, 41772, 41770, 41768, 41768, 41768, 41766, 41764, 41764
.long 41768, 41766, 41764, 41764, 41764, 41762, 41760, 41760, 41760, 41758, 41756, 41756
.long 41760, 41758, 41756, 41756, 41756, 41754, 41752, 41752, 41752, 41750, 41748, 41748
.long 41752, 41750, 41748, 41748, 41748, 41746, 41744, 41744, 41744, 41742, 41740, 41740
.long 41744, 41742, 41740, 41740, 41740, 41738, 41736, 41736, 41736, 41734, 41732, 41732
.long 41736, 41734, 41732, 41732, 41732, 41730, 41728, 41728, 41726, 41724, 41722, 41720
.long 41726, 41724, 41722, 41720, 41718, 41716, 41714, 41712, 41710, 41708, 41706, 41704
.long 41710, 41708, 41706, 41704, 41702, 41700, 41698, 41696, 41694, 41692, 41690, 41688
.long 41694, 41692, 41690, 41688, 41686, 41684, 41682, 41680, 41678, 41676, 41674, 41672
.long 41678, 41676, 41674, 41672, 41670, 41668, 41666, 41664, 41662, 41660, 41658, 41656
.long 41662, 41660, 41658, 41656, 41654, 41652, 41650, 41648, 41646, 41644, 41642, 41640
.long 41646, 41644, 41642, 41640, 41638, 41636, 41634, 41632, 41630, 41628, 41626, 41624
.long 41630, 41628, 41626, 41624, 41622, 41620, 41618, 41616, 41614, 41612, 41610, 41608
.long 41614, 41612, 41610, 41608, 41606, 41604, 41602, 41600, 41598, 41596, 41594, 41592
.long 41598, 41596, 41594, 41592, 41590, 41588, 41586, 41584, 41582, 41580, 41578, 41576
.long 41582, 41580, 41578, 41576, 41574, 41572, 41570, 41568, 41566, 41564, 41562, 41560
.long 41566, 41564, 41562, 41560, 41558, 41556, 41554, 41552, 41550, 41548, 41546, 41544
.long 41550, 41548, 41546, 41544, 41542, 41540, 41538, 41536, 41534, 41532, 41530, 41528
.long 41534, 41532, 41530, 41528, 41526, 41524, 41522, 41520, 41518, 41516, 41514, 41512
.long 41518, 41516, 41514, 41512, 41510, 41508, 41506, 41504, 41502, 41500, 41498, 41496
.long 41502, 41500, 41498, 41496, 41494, 41492, 41490, 41488, 41486, 41484, 41482, 41480
.long 41486, 41484, 41482, 41480, 41478, 41476, 41474, 41472, 41470, 41468, 41466, 41464
.long 41470, 41468, 41466, 41464, 41462, 41460, 41458, 41456, 41454, 41452, 41450, 41448
.long 41454, 41452, 41450, 41448, 41446, 41444, 41442, 41440, 41438, 41436, 41434, 41432
.long 41438, 41436, 41434, 41432, 41430, 41428, 41426, 41424, 41422, 41420, 41418, 41416
.long 41422, 41420, 41418, 41416, 41414, 41412, 41410, 41408, 41406, 41404, 41402, 41400
.long 41406, 41404, 41402, 41400, 41398, 41396, 41394, 41392, 41390, 41388, 41386, 41384
.long 41390, 41388, 41386, 41384, 41382, 41380, 41378, 41376, 41374, 41372, 41370, 41368
.long 41374, 41372, 41370, 41368, 41366, 41364, 41362, 41360, 41358, 41356, 41354, 41352
.long 41358, 41356, 41354, 41352, 41350, 41348, 41346, 41344, 41342, 41340, 41338, 41336
.long 41342, 41340, 41338, 41336, 41334, 41332, 41330, 41328, 41326, 41324, 41322, 41320
.long 41326, 41324, 41322, 41320, 41318, 41316, 41314, 41312, 41310, 41308, 41306, 41304
.long 41310, 41308, 41306, 41304, 41302, 41300, 41298, 41296, 41294, 41292, 41290, 41288
.long 41294, 41292, 41290, 41288, 41286, 41284, 41282, 41280, 41278, 41276, 41274, 41272
.long 41278, 41276, 41274, 41272, 41270, 41268, 41266, 41264, 41262, 41260, 41258, 41256
.long 41262, 41260, 41258, 41256, 41254, 41252, 41250, 41248, 41246, 41244, 41242, 41240
.long 41246, 41244, 41242, 41240, 41238, 41236, 41234, 41232, 41230, 41228, 41226, 41224
.long 41230, 41228, 41226, 41224, 41222, 41220, 41218, 41216, 42500, 42500, 42500, 42500
.size AB_gtab, 12288
.text
.globl main_kernel
.p2align 8
.type main_kernel,@function
main_kernel:
    s_cmp_ge_u32 s2, 256
    s_cbranch_scc1 M_end
    s_load_dwordx2 s[6:7], s[0:1], 112
    s_load_dwordx4 s[96:99], s[0:1], 72
    s_load_dwordx2 s[100:101], s[0:1], 96
    v_and_b32 v1, 63, v0
    v_lshrrev_b32 v2, 6, v0
    v_and_b32 v3, 15, v0
    v_readfirstlane_b32 s3, v2
    v_bfe_u32 v4, v0, 4, 2
    v_lshlrev_b32 v8, 4, v1
    s_and_b32 s37, s2, 1
    s_bfe_u32 s35, s2, 0x20001
    s_lshl_b32 s35, s35, 2
    s_bfe_u32 s36, s2, 0x20003
    s_add_u32 s35, s35, s36
    s_lshr_b32 s36, s2, 5
    s_mov_b32 s10, s35
    s_lshl_b32 s11, s36, 1
    s_add_u32 s11, s11, s37
    s_and_b32 s38, s2, 7
    s_lshl_b32 s38, s38, 2
    s_bfe_u32 s39, s2, 0x20003
    s_add_u32 s38, s38, s39
    s_and_b32 s12, s3, 3
    s_lshl_b32 s53, s10, 3
    s_lshl_b32 s54, s12, 1
    s_add_u32 s53, s53, s54
    s_cmp_lt_u32 s3, 4
    s_cbranch_scc1 M_comp
    v_lshrrev_b32 v5, 1, v3
    v_xor_b32 v6, v5, v4
    v_xor_b32 v7, 4, v6
    v_and_b32 v5, 1, v3
    v_lshl_or_b32 v6, v6, 1, v5
    v_lshl_or_b32 v7, v7, 1, v5
    s_lshl_b32 s13, s12, 4
    v_add_u32 v5, s13, v4
    v_lshlrev_b32 v5, 12, v5
    v_lshl_add_u32 v10, v6, 4, v5
    v_lshl_add_u32 v11, v7, 4, v5
    v_add_u32 v11, 15360, v11
    v_add_u32 v12, 30720, v10
    v_add_u32 v13, 30720, v11
    s_mul_i32 s48, s12, 4096
    s_mul_i32 s46, s12, 3072
    s_add_u32 s46, s46, 2048
    s_min_u32 s48, s48, s46
    v_add_u32 v14, s48, v8
    s_add_u32 s47, s48, 16384
    s_lshl_b32 s46, s12, 12
    s_lshl_b32 s44, s10, 8
    s_mov_b32 s45, 0
    s_mul_i32 s14, s11, 143360
    s_waitcnt lgkmcnt(0)
    s_add_u32 s16, s6, 2621440
    s_addc_u32 s17, s7, 0
    s_mov_b32 s18, 2621440
    s_mov_b32 s19, 0x00020000
    s_add_u32 s20, s6, s14
    s_addc_u32 s21, s7, 0
    s_add_u32 s20, s20, 8192000
    s_addc_u32 s21, s21, 0
    s_mov_b32 s22, 143360
    s_mov_b32 s23, 0x00020000
    s_lshr_b32 vcc_lo, s12, 1
    s_mov_b32 vcc_hi, 0
    s_mov_b32 s40, 2048
    s_mov_b32 s42, 0
MC_pro:
    s_add_u32 m0, s40, s46
    s_nop 0
    buffer_load_dwordx4 v10, s[16:19], s44 offen offset:0  lds
    buffer_load_dwordx4 v11, s[16:19], s44 offen offset:1024  lds
    buffer_load_dwordx4 v12, s[16:19], s44 offen offset:2048  lds
    buffer_load_dwordx4 v13, s[16:19], s44 offen offset:3072  lds
    s_add_u32 m0, s40, s47
    s_nop 0
    buffer_load_dwordx4 v14, s[20:23], s45 offen offset:0  lds
    buffer_load_dwordx4 v14, s[20:23], s45 offen offset:1024  lds
    buffer_load_dwordx4 v14, s[20:23], s45 offen offset:2048  lds
    s_cbranch_vccnz MC_sk_1
    buffer_load_dwordx4 v14, s[20:23], s45 offen offset:3072  lds
MC_sk_1:
    s_add_u32 s44, s44, 262144
    s_add_u32 s45, s45, 14336
    s_add_u32 s40, s40, 30720
    s_cmp_eq_u32 s40, 94208
    s_cselect_b32 s40, 2048, s40
    s_add_u32 s42, s42, 1
    s_cmp_lg_u32 s42, 2
    s_cbranch_scc1 MC_pro2
    s_waitcnt vmcnt(8)
    s_cbranch_vccz MC_w_2
    s_waitcnt vmcnt(7)
MC_w_2:
    s_barrier
MC_pro2:
    s_cmp_lt_u32 s42, 3
    s_cbranch_scc1 MC_pro
MC_ld:
    s_waitcnt vmcnt(8)
    s_cbranch_vccz MC_w_3
    s_waitcnt vmcnt(7)
MC_w_3:
    s_barrier
    s_add_u32 m0, s40, s46
    s_nop 0
    buffer_load_dwordx4 v10, s[16:19], s44 offen offset:0  lds
    buffer_load_dwordx4 v11, s[16:19], s44 offen offset:1024  lds
    buffer_load_dwordx4 v12, s[16:19], s44 offen offset:2048  lds
    buffer_load_dwordx4 v13, s[16:19], s44 offen offset:3072  lds
    s_add_u32 m0, s40, s47
    s_nop 0
    buffer_load_dwordx4 v14, s[20:23], s45 offen offset:0  lds
    buffer_load_dwordx4 v14, s[20:23], s45 offen offset:1024  lds
    buffer_load_dwordx4 v14, s[20:23], s45 offen offset:2048  lds
    s_cbranch_vccnz MC_sk_4
    buffer_load_dwordx4 v14, s[20:23], s45 offen offset:3072  lds
MC_sk_4:
    s_add_u32 s44, s44, 262144
    s_add_u32 s45, s45, 14336
    s_add_u32 s40, s40, 30720
    s_cmp_eq_u32 s40, 94208
    s_cselect_b32 s40, 2048, s40
    s_add_u32 s42, s42, 1
    s_cmp_lt_u32 s42, 10
    s_cbranch_scc1 MC_ld
    s_add_u32 s24, s6, 7880704
    s_addc_u32 s25, s7, 0
    s_mov_b32 s26, 35840
    s_mov_b32 s27, 0x00020000
    v_and_b32 v9, 255, v0
    v_lshlrev_b32 v9, 2, v9
    s_mul_i32 s15, s11, 448
    s_add_u32 s56, s15, 0
    buffer_load_dword v16, v9, s[24:27], s56 offen
    s_add_u32 s56, s15, 7168
    buffer_load_dword v17, v9, s[24:27], s56 offen
    s_add_u32 s56, s15, 14336
    buffer_load_dword v18, v9, s[24:27], s56 offen
    s_add_u32 s56, s15, 21504
    buffer_load_dword v19, v9, s[24:27], s56 offen
    s_add_u32 s56, s15, 28672
    buffer_load_dword v20, v9, s[24:27], s56 offen
    v_lshrrev_b32 v5, 3, v1
    v_lshrrev_b32 v6, 1, v5
    v_and_b32 v7, 7, v1
    v_xor_b32 v6, v6, v7
    v_xor_b32 v7, 4, v6
    s_lshl_b32 s56, s35, 7
    s_lshl_b32 s57, s12, 5
    s_add_u32 s56, s56, s57
    v_add_u32 v5, s56, v5
    v_lshlrev_b32 v5, 12, v5
    v_lshl_add_u32 v22, v6, 4, v5
    v_lshl_add_u32 v23, v7, 4, v5
    v_add_u32 v23, 32768, v23
    v_add_u32 v24, 65536, v22
    v_add_u32 v25, 65536, v23
    s_lshl_b32 s57, s37, 11
    s_add_u32 s57, s57, 768
    s_mov_b32 s28, s96
    s_mov_b32 s29, s97
    s_mov_b32 s30, 8388608
    s_mov_b32 s31, 0x00020000
    s_waitcnt vmcnt(13)
    s_cbranch_vccz MC_w_5
    s_waitcnt vmcnt(12)
MC_w_5:
    s_barrier
    s_waitcnt vmcnt(5)
    s_barrier
    s_waitcnt vmcnt(0)
    v_add_f32 v16, v16, v17
    v_add_f32 v18, v18, v19
    v_add_f32 v16, v16, v20
    v_add_f32 v16, v16, v18
    v_mov_b32 v17, 448
    v_cmp_gt_u32 s[58:59], v17, v9
    s_nop 3
    s_mov_b64 exec, s[58:59]
    ds_write_b32 v9, v16 offset:0
    s_mov_b64 exec, -1
    s_waitcnt lgkmcnt(0)
    s_barrier
    s_branch ML_d
    s_waitcnt vmcnt(0)
    s_barrier
    s_branch ML_d
ML_d:
    v_mov_b32 v10, v22
    v_add_u32 v11, -1024, v23
    v_add_u32 v12, -2048, v24
    v_add_u32 v13, -3072, v25
    s_lshl_b32 s44, s37, 11
    s_add_u32 s40, s46, 59392
    s_mov_b32 m0, s40
    s_nop 0
    buffer_load_dwordx4 v10, s[28:31], s44 offen offset:0  lds
    buffer_load_dwordx4 v11, s[28:31], s44 offen offset:1024  lds
    buffer_load_dwordx4 v12, s[28:31], s44 offen offset:2048  lds
    buffer_load_dwordx4 v13, s[28:31], s44 offen offset:3072  lds
    s_add_u32 s44, s44, 128
    s_add_u32 s40, s40, 16384
    s_mov_b32 m0, s40
    s_nop 0
    buffer_load_dwordx4 v10, s[28:31], s44 offen offset:0  lds
    buffer_load_dwordx4 v11, s[28:31], s44 offen offset:1024  lds
    buffer_load_dwordx4 v12, s[28:31], s44 offen offset:2048  lds
    buffer_load_dwordx4 v13, s[28:31], s44 offen offset:3072  lds
    s_add_u32 s44, s44, 128
    s_add_u32 s40, s40, 16384
    s_mov_b32 m0, s40
    s_nop 0
    buffer_load_dwordx4 v10, s[28:31], s44 offen offset:0  lds
    buffer_load_dwordx4 v11, s[28:31], s44 offen offset:1024  lds
    buffer_load_dwordx4 v12, s[28:31], s44 offen offset:2048  lds
    buffer_load_dwordx4 v13, s[28:31], s44 offen offset:3072  lds
    s_add_u32 s44, s44, 128
    s_add_u32 s40, s40, 16384
    s_mov_b32 m0, s40
    s_nop 0
    buffer_load_dwordx4 v10, s[28:31], s44 offen offset:0  lds
    buffer_load_dwordx4 v11, s[28:31], s44 offen offset:1024  lds
    buffer_load_dwordx4 v12, s[28:31], s44 offen offset:2048  lds
    buffer_load_dwordx4 v13, s[28:31], s44 offen offset:3072  lds
    s_add_u32 s44, s44, 128
    s_add_u32 s40, s40, 16384
    s_mov_b32 m0, s40
    s_nop 0
    buffer_load_dwordx4 v10, s[28:31], s44 offen offset:0  lds
    buffer_load_dwordx4 v11, s[28:31], s44 offen offset:1024  lds
    buffer_load_dwordx4 v12, s[28:31], s44 offen offset:2048  lds
    buffer_load_dwordx4 v13, s[28:31], s44 offen offset:3072  lds
    s_add_u32 s44, s44, 128
    s_add_u32 s40, s40, 16384
    s_mov_b32 m0, s40
    s_nop 0
    buffer_load_dwordx4 v10, s[28:31], s44 offen offset:0  lds
    buffer_load_dwordx4 v11, s[28:31], s44 offen offset:1024  lds
    buffer_load_dwordx4 v12, s[28:31], s44 offen offset:2048  lds
    buffer_load_dwordx4 v13, s[28:31], s44 offen offset:3072  lds
    s_add_u32 s44, s44, 128
    s_add_u32 s40, s40, 16384
    s_add_u32 s24, s6, 7929856
    s_addc_u32 s25, s7, 0
    s_mov_b32 s26, 262144
    s_mov_b32 s27, 0x00020000
    s_lshl_b32 s59, s53, 11
    s_lshl_b32 s58, s12, 7
    v_lshl_add_u32 v6, v3, 3, s58
    s_waitcnt vmcnt(0)
    s_barrier
    s_sleep 10
ML_poll:
    buffer_load_dwordx4 v[64:67], v8, s[24:27], s59 offen offset:0 sc1
    buffer_load_dwordx4 v[68:71], v8, s[24:27], s59 offen offset:1024 sc1
    buffer_load_dwordx4 v[72:75], v8, s[24:27], s59 offen offset:2048 sc1
    buffer_load_dwordx4 v[76:79], v8, s[24:27], s59 offen offset:3072 sc1
    s_waitcnt vmcnt(0)
    v_or3_b32 v30, v65, v67, v69
    v_or3_b32 v31, v71, v73, v75
    v_or3_b32 v30, v30, v77, v79
    v_or_b32 v30, v30, v31
    v_cmp_gt_i32 vcc, 0, v30
    s_nop 3
    s_cbranch_vccz ML_rA
    s_sleep 3
    s_branch ML_poll
ML_rA:
    s_setprio 2
    v_pk_add_f32 v[32:33], v[64:65], v[68:69]
    v_pk_add_f32 v[34:35], v[66:67], v[70:71]
    v_pk_add_f32 v[40:41], v[72:73], v[76:77]
    v_pk_add_f32 v[42:43], v[74:75], v[78:79]
    v_pk_add_f32 v[32:33], v[32:33], v[40:41]
    v_pk_add_f32 v[34:35], v[34:35], v[42:43]
    v_mov_b32 v36, v32
    v_mov_b32 v37, v33
    v_mov_b32 v38, v34
    v_mov_b32 v39, v35
    v_permlane16_swap_b32 v32, v36
    v_permlane16_swap_b32 v33, v37
    v_permlane16_swap_b32 v34, v38
    v_permlane16_swap_b32 v35, v39
    v_add_f32 v32, v32, v36
    v_add_f32 v33, v33, v37
    v_add_f32 v34, v34, v38
    v_add_f32 v35, v35, v39
    v_mov_b32 v36, v32
    v_mov_b32 v37, v33
    v_mov_b32 v38, v34
    v_mov_b32 v39, v35
    v_permlane32_swap_b32 v32, v36
    v_permlane32_swap_b32 v33, v37
    v_permlane32_swap_b32 v34, v38
    v_permlane32_swap_b32 v35, v39
    v_add_f32 v32, v32, v36
    v_add_f32 v33, v33, v37
    v_add_f32 v34, v34, v38
    v_add_f32 v35, v35, v39
    v_mul_f32 v32, 0x3a97b426, v32
    v_mul_f32 v33, 0x3a97b426, v33
    v_mul_f32 v34, 0x3a97b426, v34
    v_mul_f32 v35, 0x3a97b426, v35
    v_fma_f32 v33, -v32, v32, v33
    v_fma_f32 v35, -v34, v34, v35
    v_max_f32 v33, 0, v33
    v_max_f32 v35, 0, v35
    v_cvt_pk_bf16_f32 v33, v33, v33
    v_lshlrev_b32 v33, 16, v33
    v_cvt_pk_bf16_f32 v35, v35, v35
    v_lshlrev_b32 v35, 16, v35
    v_add_f32 v33, 0x3727c5ac, v33
    v_add_f32 v35, 0x3727c5ac, v35
    v_cvt_pk_bf16_f32 v33, v33, v33
    v_lshlrev_b32 v33, 16, v33
    v_cvt_pk_bf16_f32 v35, v35, v35
    v_lshlrev_b32 v35, 16, v35
    v_sqrt_f32 v33, v33
    v_sqrt_f32 v35, v35
    v_cvt_pk_bf16_f32 v32, v32, v32
    v_lshlrev_b32 v32, 16, v32
    v_cvt_pk_bf16_f32 v34, v34, v34
    v_lshlrev_b32 v34, 16, v34
    v_cvt_pk_bf16_f32 v33, v33, v33
    v_lshlrev_b32 v33, 16, v33
    v_cvt_pk_bf16_f32 v35, v35, v35
    v_lshlrev_b32 v35, 16, v35
    v_rcp_f32 v33, v33
    v_rcp_f32 v35, v35
    ds_write2_b32 v6, v32, v34 offset0:128 offset1:129
    v_add_u32 v6, 512, v6
    ds_write2_b32 v6, v33, v35 offset0:128 offset1:129
    s_setprio 0
    s_waitcnt lgkmcnt(0)
    s_barrier
    s_mul_i32 s14, s36, 458752
    s_mul_i32 s45, s37, 229376
    s_add_u32 s41, s48, 2048
    s_lshr_b32 vcc_lo, s12, 1
    s_mov_b32 vcc_hi, 0
    s_add_u32 s20, s6, s14
    s_addc_u32 s21, s7, 0
    s_add_u32 s20, s20, 15269888
    s_addc_u32 s21, s21, 0
    s_mov_b32 s22, 458752
    s_mov_b32 s23, 0x00020000
    s_mul_i32 s14, s36, 143360
    s_add_u32 s84, s6, s14
    s_addc_u32 s85, s7, 0
    s_add_u32 s84, s84, 34865152
    s_addc_u32 s85, s85, 0
    s_mov_b32 s86, 143360
    s_mov_b32 s87, 0x00020000
    s_lshr_b32 s14, s11, 1
    s_lshl_b32 s14, s14, 5
    s_lshl_b32 s15, s10, 1
    s_add_u32 s14, s14, s15
    s_and_b32 s15, s11, 1
    s_add_u32 s14, s14, s15
    s_lshl_b32 s14, s14, 7
    s_add_u32 s14, s14, 43384832
    s_sub_u32 s55, s14, 43384832
    s_xor_b32 s55, s55, 128
    s_add_u32 s55, s55, 43384832
    s_xor_b32 s55, s55, 128
    v_mov_b32 v5, s14
    v_mov_b32 v6, 1
    s_lshl_b32 s14, s36, 12
    s_add_u32 s14, s14, 43384832
    s_lshl_b32 s15, s37, 11
    s_add_u32 s15, s15, s14
    v_lshl_add_u32 v7, v3, 7, s15
    s_xor_b32 s14, s55, 128
    v_mov_b32 v9, s14
    v_cmp_gt_u32 s[58:59], 16, v1
    s_nop 1
    v_cndmask_b32 v7, v9, v7, s[58:59]
    v_add_u32 v26, s46, v8
    v_add_u32 v27, 59392, v26
    v_add_u32 v28, 108544, v26
    v_add_u32 v29, 2048, v26
    s_barrier
    s_cmp_lg_u32 s3, 4
    s_cbranch_scc1 ML_rest
    s_mov_b64 exec, 1
    global_store_dword v5, v6, s[6:7] sc1
    s_mov_b64 exec, -1
ML_fp:
    global_load_dword v9, v7, s[6:7] sc1
    s_waitcnt vmcnt(0)
    v_cmp_ne_u32 s[58:59], 1, v9
    s_nop 3
    s_cmp_eq_u64 s[58:59], 0
    s_cbranch_scc1 ML_z4
    s_sleep 3
    s_branch ML_fp
ML_z4:
    s_barrier
ML_rest:
    s_cmp_eq_u32 s3, 4
    s_cbranch_scc1 ML_z
    s_barrier
ML_z:
    s_add_u32 m0, s41, 0
    s_nop 0
    buffer_load_dwordx4 v14, s[20:23], s45 offen offset:0 sc1 lds
    buffer_load_dwordx4 v14, s[20:23], s45 offen offset:1024 sc1 lds
    buffer_load_dwordx4 v14, s[20:23], s45 offen offset:2048 sc1 lds
    s_cbranch_vccnz ML_sk_6
    buffer_load_dwordx4 v14, s[20:23], s45 offen offset:3072 sc1 lds
ML_sk_6:
    s_add_u32 s45, s45, 14336
    s_add_u32 m0, s41, 14336
    s_nop 0
    buffer_load_dwordx4 v14, s[20:23], s45 offen offset:0 sc1 lds
    buffer_load_dwordx4 v14, s[20:23], s45 offen offset:1024 sc1 lds
    buffer_load_dwordx4 v14, s[20:23], s45 offen offset:2048 sc1 lds
    s_cbranch_vccnz ML_sk_7
    buffer_load_dwordx4 v14, s[20:23], s45 offen offset:3072 sc1 lds
ML_sk_7:
    s_add_u32 s45, s45, 14336
    s_waitcnt vmcnt(4)
    s_cbranch_vccz ML_w_8
    s_waitcnt vmcnt(3)
ML_w_8:
    s_barrier
    s_add_u32 m0, s41, 28672
    s_nop 0
    buffer_load_dwordx4 v14, s[20:23], s45 offen offset:0 sc1 lds
    buffer_load_dwordx4 v14, s[20:23], s45 offen offset:1024 sc1 lds
    buffer_load_dwordx4 v14, s[20:23], s45 offen offset:2048 sc1 lds
    s_cbranch_vccnz ML_sk_9
    buffer_load_dwordx4 v14, s[20:23], s45 offen offset:3072 sc1 lds
ML_sk_9:
    s_add_u32 s45, s45, 14336
    s_waitcnt vmcnt(4)
    s_cbranch_vccz ML_w_10
    s_waitcnt vmcnt(3)
ML_w_10:
    s_barrier
    s_add_u32 m0, s41, 43008
    s_nop 0
    buffer_load_dwordx4 v14, s[20:23], s45 offen offset:0 sc1 lds
    buffer_load_dwordx4 v14, s[20:23], s45 offen offset:1024 sc1 lds
    buffer_load_dwordx4 v14, s[20:23], s45 offen offset:2048 sc1 lds
    s_cbranch_vccnz ML_sk_11
    buffer_load_dwordx4 v14, s[20:23], s45 offen offset:3072 sc1 lds
ML_sk_11:
    s_add_u32 s45, s45, 14336
    s_add_u32 m0, s46, 59392
    s_nop 0
    buffer_load_dwordx4 v10, s[28:31], s44 offen offset:0  lds
    buffer_load_dwordx4 v11, s[28:31], s44 offen offset:1024  lds
    buffer_load_dwordx4 v12, s[28:31], s44 offen offset:2048  lds
    buffer_load_dwordx4 v13, s[28:31], s44 offen offset:3072  lds
    s_add_u32 s44, s44, 128
    s_waitcnt vmcnt(8)
    s_cbranch_vccz ML_w_12
    s_waitcnt vmcnt(7)
ML_w_12:
    s_barrier
    s_add_u32 m0, s41, 0
    s_nop 0
    buffer_load_dwordx4 v14, s[20:23], s45 offen offset:0 sc1 lds
    buffer_load_dwordx4 v14, s[20:23], s45 offen offset:1024 sc1 lds
    buffer_load_dwordx4 v14, s[20:23], s45 offen offset:2048 sc1 lds
    s_cbranch_vccnz ML_sk_13
    buffer_load_dwordx4 v14, s[20:23], s45 offen offset:3072 sc1 lds
ML_sk_13:
    s_add_u32 s45, s45, 14336
    s_add_u32 m0, s46, 75776
    s_nop 0
    buffer_load_dwordx4 v10, s[28:31], s44 offen offset:0  lds
    buffer_load_dwordx4 v11, s[28:31], s44 offen offset:1024  lds
    buffer_load_dwordx4 v12, s[28:31], s44 offen offset:2048  lds
    buffer_load_dwordx4 v13, s[28:31], s44 offen offset:3072  lds
    s_add_u32 s44, s44, 128
    s_waitcnt vmcnt(12)
    s_cbranch_vccz ML_w_14
    s_waitcnt vmcnt(11)
ML_w_14:
    s_barrier
    s_add_u32 m0, s41, 14336
    s_nop 0
    buffer_load_dwordx4 v14, s[20:23], s45 offen offset:0 sc1 lds
    buffer_load_dwordx4 v14, s[20:23], s45 offen offset:1024 sc1 lds
    buffer_load_dwordx4 v14, s[20:23], s45 offen offset:2048 sc1 lds
    s_cbranch_vccnz ML_sk_15
    buffer_load_dwordx4 v14, s[20:23], s45 offen offset:3072 sc1 lds
ML_sk_15:
    s_add_u32 s45, s45, 14336
    s_add_u32 m0, s46, 92160
    s_nop 0
    buffer_load_dwordx4 v10, s[28:31], s44 offen offset:0  lds
    buffer_load_dwordx4 v11, s[28:31], s44 offen offset:1024  lds
    buffer_load_dwordx4 v12, s[28:31], s44 offen offset:2048  lds
    buffer_load_dwordx4 v13, s[28:31], s44 offen offset:3072  lds
    s_add_u32 s44, s44, 128
    s_waitcnt vmcnt(12)
    s_cbranch_vccz ML_w_16
    s_waitcnt vmcnt(11)
ML_w_16:
    s_barrier
    s_add_u32 m0, s41, 28672
    s_nop 0
    buffer_load_dwordx4 v14, s[20:23], s45 offen offset:0 sc1 lds
    buffer_load_dwordx4 v14, s[20:23], s45 offen offset:1024 sc1 lds
    buffer_load_dwordx4 v14, s[20:23], s45 offen offset:2048 sc1 lds
    s_cbranch_vccnz ML_sk_17
    buffer_load_dwordx4 v14, s[20:23], s45 offen offset:3072 sc1 lds
ML_sk_17:
    s_add_u32 s45, s45, 14336
    s_add_u32 m0, s46, 108544
    s_nop 0
    buffer_load_dwordx4 v10, s[28:31], s44 offen offset:0  lds
    buffer_load_dwordx4 v11, s[28:31], s44 offen offset:1024  lds
    buffer_load_dwordx4 v12, s[28:31], s44 offen offset:2048  lds
    buffer_load_dwordx4 v13, s[28:31], s44 offen offset:3072  lds
    s_add_u32 s44, s44, 128
    s_waitcnt vmcnt(12)
    s_cbranch_vccz ML_w_18
    s_waitcnt vmcnt(11)
ML_w_18:
    s_barrier
    s_add_u32 m0, s41, 43008
    s_nop 0
    buffer_load_dwordx4 v14, s[20:23], s45 offen offset:0 sc1 lds
    buffer_load_dwordx4 v14, s[20:23], s45 offen offset:1024 sc1 lds
    buffer_load_dwordx4 v14, s[20:23], s45 offen offset:2048 sc1 lds
    s_cbranch_vccnz ML_sk_19
    buffer_load_dwordx4 v14, s[20:23], s45 offen offset:3072 sc1 lds
ML_sk_19:
    s_add_u32 s45, s45, 14336
    s_add_u32 m0, s46, 124928
    s_nop 0
    buffer_load_dwordx4 v10, s[28:31], s44 offen offset:0  lds
    buffer_load_dwordx4 v11, s[28:31], s44 offen offset:1024  lds
    buffer_load_dwordx4 v12, s[28:31], s44 offen offset:2048  lds
    buffer_load_dwordx4 v13, s[28:31], s44 offen offset:3072  lds
    s_add_u32 s44, s44, 128
    s_waitcnt vmcnt(12)
    s_cbranch_vccz ML_w_20
    s_waitcnt vmcnt(11)
ML_w_20:
    s_barrier
    s_add_u32 m0, s41, 0
    s_nop 0
    buffer_load_dwordx4 v14, s[20:23], s45 offen offset:0 sc1 lds
    buffer_load_dwordx4 v14, s[20:23], s45 offen offset:1024 sc1 lds
    buffer_load_dwordx4 v14, s[20:23], s45 offen offset:2048 sc1 lds
    s_cbranch_vccnz ML_sk_21
    buffer_load_dwordx4 v14, s[20:23], s45 offen offset:3072 sc1 lds
ML_sk_21:
    s_add_u32 s45, s45, 14336
    s_add_u32 m0, s46, 141312
    s_nop 0
    buffer_load_dwordx4 v10, s[28:31], s44 offen offset:0  lds
    buffer_load_dwordx4 v11, s[28:31], s44 offen offset:1024  lds
    buffer_load_dwordx4 v12, s[28:31], s44 offen offset:2048  lds
    buffer_load_dwordx4 v13, s[28:31], s44 offen offset:3072  lds
    s_add_u32 s44, s44, 128
    s_waitcnt vmcnt(12)
    s_cbranch_vccz ML_w_22
    s_waitcnt vmcnt(11)
ML_w_22:
    s_barrier
    s_add_u32 m0, s41, 14336
    s_nop 0
    buffer_load_dwordx4 v14, s[20:23], s45 offen offset:0 sc1 lds
    buffer_load_dwordx4 v14, s[20:23], s45 offen offset:1024 sc1 lds
    buffer_load_dwordx4 v14, s[20:23], s45 offen offset:2048 sc1 lds
    s_cbranch_vccnz ML_sk_23
    buffer_load_dwordx4 v14, s[20:23], s45 offen offset:3072 sc1 lds
ML_sk_23:
    s_add_u32 s45, s45, 14336
    s_add_u32 m0, s46, 59392
    s_nop 0
    buffer_load_dwordx4 v10, s[28:31], s44 offen offset:0  lds
    buffer_load_dwordx4 v11, s[28:31], s44 offen offset:1024  lds
    buffer_load_dwordx4 v12, s[28:31], s44 offen offset:2048  lds
    buffer_load_dwordx4 v13, s[28:31], s44 offen offset:3072  lds
    s_add_u32 s44, s44, 128
    s_waitcnt vmcnt(12)
    s_cbranch_vccz ML_w_24
    s_waitcnt vmcnt(11)
ML_w_24:
    s_barrier
    s_add_u32 m0, s41, 28672
    s_nop 0
    buffer_load_dwordx4 v14, s[20:23], s45 offen offset:0 sc1 lds
    buffer_load_dwordx4 v14, s[20:23], s45 offen offset:1024 sc1 lds
    buffer_load_dwordx4 v14, s[20:23], s45 offen offset:2048 sc1 lds
    s_cbranch_vccnz ML_sk_25
    buffer_load_dwordx4 v14, s[20:23], s45 offen offset:3072 sc1 lds
ML_sk_25:
    s_add_u32 s45, s45, 14336
    s_add_u32 m0, s46, 75776
    s_nop 0
    buffer_load_dwordx4 v10, s[28:31], s44 offen offset:0  lds
    buffer_load_dwordx4 v11, s[28:31], s44 offen offset:1024  lds
    buffer_load_dwordx4 v12, s[28:31], s44 offen offset:2048  lds
    buffer_load_dwordx4 v13, s[28:31], s44 offen offset:3072  lds
    s_add_u32 s44, s44, 128
    s_waitcnt vmcnt(12)
    s_cbranch_vccz ML_w_26
    s_waitcnt vmcnt(11)
ML_w_26:
    s_barrier
    s_add_u32 m0, s41, 43008
    s_nop 0
    buffer_load_dwordx4 v14, s[20:23], s45 offen offset:0 sc1 lds
    buffer_load_dwordx4 v14, s[20:23], s45 offen offset:1024 sc1 lds
    buffer_load_dwordx4 v14, s[20:23], s45 offen offset:2048 sc1 lds
    s_cbranch_vccnz ML_sk_27
    buffer_load_dwordx4 v14, s[20:23], s45 offen offset:3072 sc1 lds
ML_sk_27:
    s_add_u32 s45, s45, 14336
    s_add_u32 m0, s46, 92160
    s_nop 0
    buffer_load_dwordx4 v10, s[28:31], s44 offen offset:0  lds
    buffer_load_dwordx4 v11, s[28:31], s44 offen offset:1024  lds
    buffer_load_dwordx4 v12, s[28:31], s44 offen offset:2048  lds
    buffer_load_dwordx4 v13, s[28:31], s44 offen offset:3072  lds
    s_add_u32 s44, s44, 128
    s_waitcnt vmcnt(12)
    s_cbranch_vccz ML_w_28
    s_waitcnt vmcnt(11)
ML_w_28:
    s_barrier
    s_add_u32 m0, s41, 0
    s_nop 0
    buffer_load_dwordx4 v14, s[20:23], s45 offen offset:0 sc1 lds
    buffer_load_dwordx4 v14, s[20:23], s45 offen offset:1024 sc1 lds
    buffer_load_dwordx4 v14, s[20:23], s45 offen offset:2048 sc1 lds
    s_cbranch_vccnz ML_sk_29
    buffer_load_dwordx4 v14, s[20:23], s45 offen offset:3072 sc1 lds
ML_sk_29:
    s_add_u32 s45, s45, 14336
    s_add_u32 m0, s46, 108544
    s_nop 0
    buffer_load_dwordx4 v10, s[28:31], s44 offen offset:0  lds
    buffer_load_dwordx4 v11, s[28:31], s44 offen offset:1024  lds
    buffer_load_dwordx4 v12, s[28:31], s44 offen offset:2048  lds
    buffer_load_dwordx4 v13, s[28:31], s44 offen offset:3072  lds
    s_add_u32 s44, s44, 128
    s_waitcnt vmcnt(12)
    s_cbranch_vccz ML_w_30
    s_waitcnt vmcnt(11)
ML_w_30:
    s_barrier
    s_add_u32 m0, s41, 14336
    s_nop 0
    buffer_load_dwordx4 v14, s[20:23], s45 offen offset:0 sc1 lds
    buffer_load_dwordx4 v14, s[20:23], s45 offen offset:1024 sc1 lds
    buffer_load_dwordx4 v14, s[20:23], s45 offen offset:2048 sc1 lds
    s_cbranch_vccnz ML_sk_31
    buffer_load_dwordx4 v14, s[20:23], s45 offen offset:3072 sc1 lds
ML_sk_31:
    s_add_u32 s45, s45, 14336
    s_add_u32 m0, s46, 124928
    s_mov_b32 s44, 65536
    buffer_load_dwordx4 v26, s[84:87], s44 offen offset:0 lds
    buffer_load_dwordx4 v26, s[84:87], s44 offen offset:1024 lds
    buffer_load_dwordx4 v26, s[84:87], s44 offen offset:2048 lds
    buffer_load_dwordx4 v26, s[84:87], s44 offen offset:3072 lds
    s_waitcnt vmcnt(12)
    s_cbranch_vccz ML_w_32
    s_waitcnt vmcnt(11)
ML_w_32:
    s_barrier
    s_add_u32 m0, s41, 28672
    s_nop 0
    buffer_load_dwordx4 v14, s[20:23], s45 offen offset:0 sc1 lds
    buffer_load_dwordx4 v14, s[20:23], s45 offen offset:1024 sc1 lds
    buffer_load_dwordx4 v14, s[20:23], s45 offen offset:2048 sc1 lds
    s_cbranch_vccnz ML_sk_33
    buffer_load_dwordx4 v14, s[20:23], s45 offen offset:3072 sc1 lds
ML_sk_33:
    s_add_u32 s45, s45, 14336
    s_add_u32 m0, s46, 141312
    s_mov_b32 s44, 81920
    buffer_load_dwordx4 v26, s[84:87], s44 offen offset:0 lds
    buffer_load_dwordx4 v26, s[84:87], s44 offen offset:1024 lds
    buffer_load_dwordx4 v26, s[84:87], s44 offen offset:2048 lds
    buffer_load_dwordx4 v26, s[84:87], s44 offen offset:3072 lds
    s_waitcnt vmcnt(12)
    s_cbranch_vccz ML_w_34
    s_waitcnt vmcnt(11)
ML_w_34:
    s_barrier
    s_add_u32 m0, s41, 43008
    s_nop 0
    buffer_load_dwordx4 v14, s[20:23], s45 offen offset:0 sc1 lds
    buffer_load_dwordx4 v14, s[20:23], s45 offen offset:1024 sc1 lds
    buffer_load_dwordx4 v14, s[20:23], s45 offen offset:2048 sc1 lds
    s_cbranch_vccnz ML_sk_35
    buffer_load_dwordx4 v14, s[20:23], s45 offen offset:3072 sc1 lds
ML_sk_35:
    s_add_u32 s45, s45, 14336
    s_add_u32 m0, s46, 59392
    s_mov_b32 s44, 0
    buffer_load_dwordx4 v26, s[84:87], s44 offen offset:0 lds
    buffer_load_dwordx4 v26, s[84:87], s44 offen offset:1024 lds
    buffer_load_dwordx4 v26, s[84:87], s44 offen offset:2048 lds
    buffer_load_dwordx4 v26, s[84:87], s44 offen offset:3072 lds
    s_waitcnt vmcnt(12)
    s_cbranch_vccz ML_w_36
    s_waitcnt vmcnt(11)
ML_w_36:
    s_barrier
    s_add_u32 m0, s46, 75776
    s_mov_b32 s44, 16384
    buffer_load_dwordx4 v26, s[84:87], s44 offen offset:0 lds
    buffer_load_dwordx4 v26, s[84:87], s44 offen offset:1024 lds
    buffer_load_dwordx4 v26, s[84:87], s44 offen offset:2048 lds
    buffer_load_dwordx4 v26, s[84:87], s44 offen offset:3072 lds
    s_waitcnt vmcnt(8)
    s_barrier
    s_add_u32 m0, s46, 92160
    s_mov_b32 s44, 32768
    buffer_load_dwordx4 v26, s[84:87], s44 offen offset:0 lds
    buffer_load_dwordx4 v26, s[84:87], s44 offen offset:1024 lds
    buffer_load_dwordx4 v26, s[84:87], s44 offen offset:2048 lds
    buffer_load_dwordx4 v26, s[84:87], s44 offen offset:3072 lds
    s_barrier
    s_add_u32 m0, s46, 108544
    s_mov_b32 s44, 49152
    buffer_load_dwordx4 v26, s[84:87], s44 offen offset:0 lds
    buffer_load_dwordx4 v26, s[84:87], s44 offen offset:1024 lds
    buffer_load_dwordx4 v26, s[84:87], s44 offen offset:2048 lds
    buffer_load_dwordx4 v26, s[84:87], s44 offen offset:3072 lds
    s_waitcnt vmcnt(0)
    s_add_u32 s28, s6, 2621440
    s_addc_u32 s29, s7, 0
    s_mov_b32 s30, 2621440
    s_mov_b32 s31, 0x00020000
    s_mul_i32 s13, s36, 5
    s_add_u32 s13, s13, 3
    s_lshl_b32 s13, s13, 16
    s_lshl_b32 s14, s38, 2
    s_add_u32 s14, s14, s12
    s_lshl_b32 s14, s14, 5
    s_add_u32 s13, s13, s14
    v_lshlrev_b32 v11, 12, v3
    v_lshl_add_u32 v11, v4, 3, v11
    buffer_load_dwordx2 v[16:17], v11, s[28:31], s13 offen
    s_add_u32 s13, s13, 65536
    buffer_load_dwordx2 v[18:19], v11, s[28:31], s13 offen
    s_add_u32 s13, s13, 65536
    s_barrier
    s_add_u32 m0, s46, 2048
    s_mov_b32 s44, 98304
    buffer_load_dwordx4 v26, s[84:87], s44 offen offset:0 lds
    buffer_load_dwordx4 v26, s[84:87], s44 offen offset:1024 lds
    buffer_load_dwordx4 v26, s[84:87], s44 offen offset:2048 lds
    buffer_load_dwordx4 v26, s[84:87], s44 offen offset:3072 lds
    s_add_u32 m0, s46, 18432
    s_mov_b32 s44, 114688
    buffer_load_dwordx4 v26, s[84:87], s44 offen offset:0 lds
    buffer_load_dwordx4 v26, s[84:87], s44 offen offset:1024 lds
    buffer_load_dwordx4 v26, s[84:87], s44 offen offset:2048 lds
    buffer_load_dwordx4 v26, s[84:87], s44 offen offset:3072 lds
    s_cmp_eq_u32 s12, 3
    s_cbranch_scc1 ML_odone
    s_add_u32 m0, s46, 34816
    s_mov_b32 s44, 131072
    buffer_load_dwordx4 v26, s[84:87], s44 offen offset:0 lds
    buffer_load_dwordx4 v26, s[84:87], s44 offen offset:1024 lds
    buffer_load_dwordx4 v26, s[84:87], s44 offen offset:2048 lds
    buffer_load_dwordx4 v26, s[84:87], s44 offen offset:3072 lds
ML_odone:
    s_waitcnt vmcnt(0)
    s_branch M_e
M_comp:
    v_lshlrev_b32 v9, 2, v0
    s_mul_i32 s15, s11, 448
    v_bfe_u32 v5, v1, 2, 2
    v_lshl_add_u32 v6, v4, 2, v5
    v_and_b32 v7, 7, v6
    s_lshl_b32 s28, s12, 1
    v_xor_b32 v7, s28, v7
    v_lshlrev_b32 v6, 8, v6
    v_lshl_add_u32 v6, v7, 5, v6
    v_and_b32 v5, 3, v1
    v_lshl_add_u32 v20, v5, 3, v6
    v_xor_b32 v21, 32, v20
    s_mov_b32 s52, 0x3f803f80
    v_mov_b32 v32, 0
    v_mov_b32 v33, 0
    v_mov_b32 v34, 0
    v_mov_b32 v35, 0
    v_mov_b32 v36, 0
    v_mov_b32 v37, 0
    v_mov_b32 v38, 0
    v_mov_b32 v39, 0
    v_mov_b32 v40, 0
    v_mov_b32 v41, 0
    v_mov_b32 v42, 0
    v_mov_b32 v43, 0
    v_mov_b32 v44, 0
    v_mov_b32 v45, 0
    v_mov_b32 v46, 0
    v_mov_b32 v47, 0
    v_mov_b32 v48, 0
    v_mov_b32 v49, 0
    v_mov_b32 v50, 0
    v_mov_b32 v51, 0
    v_mov_b32 v52, 0
    v_mov_b32 v53, 0
    v_mov_b32 v54, 0
    v_mov_b32 v55, 0
    v_mov_b32 v56, 0
    v_mov_b32 v57, 0
    v_mov_b32 v58, 0
    v_mov_b32 v59, 0
    v_mov_b32 v60, 0
    v_mov_b32 v61, 0
    v_mov_b32 v62, 0
    v_mov_b32 v63, 0
    v_mov_b32 v64, 0
    v_mov_b32 v65, 0
    v_mov_b32 v66, 0
    v_mov_b32 v67, 0
    v_mov_b32 v68, 0
    v_mov_b32 v69, 0
    v_mov_b32 v70, 0
    v_mov_b32 v71, 0
    v_mov_b32 v72, 0
    v_mov_b32 v73, 0
    v_mov_b32 v74, 0
    v_mov_b32 v75, 0
    v_mov_b32 v76, 0
    v_mov_b32 v77, 0
    v_mov_b32 v78, 0
    v_mov_b32 v79, 0
    v_mov_b32 v80, 0
    v_mov_b32 v81, 0
    v_mov_b32 v82, 0
    v_mov_b32 v83, 0
    v_mov_b32 v84, 0
    v_mov_b32 v85, 0
    v_mov_b32 v86, 0
    v_mov_b32 v87, 0
    v_mov_b32 v88, 0
    v_mov_b32 v89, 0
    v_mov_b32 v90, 0
    v_mov_b32 v91, 0
    v_mov_b32 v92, 0
    v_mov_b32 v93, 0
    v_mov_b32 v94, 0
    v_mov_b32 v95, 0
    v_mov_b32 v96, 0
    v_mov_b32 v97, 0
    v_mov_b32 v98, 0
    v_mov_b32 v99, 0
    v_mov_b32 v100, 0
    v_mov_b32 v101, 0
    v_mov_b32 v102, 0
    v_mov_b32 v103, 0
    v_mov_b32 v104, s52
    v_mov_b32 v105, s52
    v_mov_b32 v106, s52
    v_mov_b32 v107, s52
    s_mul_i32 s54, s53, 20
    s_lshl_b32 s55, s11, 1
    s_add_u32 s54, s54, s55
    s_lshl_b32 s54, s54, 10
    s_add_u32 s55, s54, 20480
    s_waitcnt lgkmcnt(0)
    s_add_u32 s28, s6, 5242880
    s_addc_u32 s29, s7, 0
    s_mov_b32 s30, 2621440
    s_mov_b32 s31, 0x00020000
    s_add_u32 s20, s6, 11599872
    s_addc_u32 s21, s7, 0
    s_mov_b32 s22, 3670016
    s_mov_b32 s23, 0x00020000
    s_lshr_b32 s16, s2, 1
    s_lshl_b32 s16, s16, 2
    s_add_u32 s16, s16, s12
    s_mul_i32 s48, s16, 7168
    s_xor_b32 s16, s37, 1
    s_lshl_b32 s16, s16, 12
    s_add_u32 s48, s48, s16
    v_mov_b32 v16, -1
    v_mov_b32 v17, -1
    v_mov_b32 v18, -1
    v_mov_b32 v19, -1
    s_mov_b32 s41, 2048
    s_mov_b32 s42, 0
    v_add_u32 v23, s41, v20
    v_add_u32 v24, s41, v21
    v_add_u32 v25, s41, v8
    s_barrier
    ds_read_b64_tr_b16 v[108:109], v23 offset:0
    ds_read_b64_tr_b16 v[110:111], v23 offset:4096
    ds_read_b64_tr_b16 v[112:113], v24 offset:0
    ds_read_b64_tr_b16 v[114:115], v24 offset:4096
    ds_read_b128 v[124:127], v25 offset:16384
    ds_read_b128 v[128:131], v25 offset:18432
    ds_read_b128 v[132:135], v25 offset:20480
    ds_read_b128 v[136:139], v25 offset:22528
    ds_read_b128 v[140:143], v25 offset:24576
    ds_read_b128 v[144:147], v25 offset:26624
    ds_read_b128 v[148:151], v25 offset:28672
    ds_read_b64_tr_b16 v[116:117], v23 offset:8192
    ds_read_b64_tr_b16 v[118:119], v23 offset:12288
    ds_read_b64_tr_b16 v[120:121], v24 offset:8192
    ds_read_b64_tr_b16 v[122:123], v24 offset:12288
    ds_read_b128 v[152:155], v25 offset:17408
    ds_read_b128 v[156:159], v25 offset:19456
    ds_read_b128 v[160:163], v25 offset:21504
    ds_read_b128 v[164:167], v25 offset:23552
    ds_read_b128 v[168:171], v25 offset:25600
    ds_read_b128 v[172:175], v25 offset:27648
    ds_read_b128 v[176:179], v25 offset:29696
    s_add_u32 s41, s41, 30720
    s_cmp_eq_u32 s41, 94208
    s_cselect_b32 s41, 2048, s41
    v_add_u32 v23, s41, v20
    v_add_u32 v24, s41, v21
    v_add_u32 v25, s41, v8
MC_loop:
    s_waitcnt lgkmcnt(0)
    s_barrier
    v_mfma_f32_16x16x32_bf16 v[32:35], v[124:127], v[108:111], v[32:35]
    ds_read_b64_tr_b16 v[180:181], v23 offset:0
    ds_read_b64_tr_b16 v[182:183], v23 offset:4096
    v_mfma_f32_16x16x32_bf16 v[36:39], v[124:127], v[112:115], v[36:39]
    ds_read_b64_tr_b16 v[184:185], v24 offset:0
    v_mfma_f32_16x16x32_bf16 v[40:43], v[128:131], v[108:111], v[40:43]
    ds_read_b64_tr_b16 v[186:187], v24 offset:4096
    v_mfma_f32_16x16x32_bf16 v[44:47], v[128:131], v[112:115], v[44:47]
    ds_read_b128 v[196:199], v25 offset:16384
    v_mfma_f32_16x16x32_bf16 v[48:51], v[132:135], v[108:111], v[48:51]
    ds_read_b128 v[200:203], v25 offset:18432
    ds_read_b128 v[204:207], v25 offset:20480
    v_mfma_f32_16x16x32_bf16 v[52:55], v[132:135], v[112:115], v[52:55]
    ds_read_b128 v[208:211], v25 offset:22528
    v_mfma_f32_16x16x32_bf16 v[56:59], v[136:139], v[108:111], v[56:59]
    ds_read_b128 v[212:215], v25 offset:24576
    v_mfma_f32_16x16x32_bf16 v[60:63], v[136:139], v[112:115], v[60:63]
    ds_read_b128 v[216:219], v25 offset:26624
    v_mfma_f32_16x16x32_bf16 v[64:67], v[140:143], v[108:111], v[64:67]
    ds_read_b128 v[220:223], v25 offset:28672
    v_mfma_f32_16x16x32_bf16 v[68:71], v[140:143], v[112:115], v[68:71]
    ds_read_b64_tr_b16 v[188:189], v23 offset:8192
    ds_read_b64_tr_b16 v[190:191], v23 offset:12288
    v_mfma_f32_16x16x32_bf16 v[72:75], v[144:147], v[108:111], v[72:75]
    ds_read_b64_tr_b16 v[192:193], v24 offset:8192
    v_mfma_f32_16x16x32_bf16 v[76:79], v[144:147], v[112:115], v[76:79]
    ds_read_b64_tr_b16 v[194:195], v24 offset:12288
    v_mfma_f32_16x16x32_bf16 v[80:83], v[148:151], v[108:111], v[80:83]
    ds_read_b128 v[224:227], v25 offset:17408
    v_mfma_f32_16x16x32_bf16 v[84:87], v[148:151], v[112:115], v[84:87]
    ds_read_b128 v[228:231], v25 offset:19456
    ds_read_b128 v[232:235], v25 offset:21504
    v_mfma_f32_16x16x32_bf16 v[88:91], v[104:107], v[108:111], v[88:91]
    ds_read_b128 v[236:239], v25 offset:23552
    v_mfma_f32_16x16x32_bf16 v[96:99], v[108:111], v[108:111], v[96:99]
    ds_read_b128 v[240:243], v25 offset:25600
    v_mfma_f32_16x16x32_bf16 v[92:95], v[104:107], v[112:115], v[92:95]
    ds_read_b128 v[244:247], v25 offset:27648
    v_mfma_f32_16x16x32_bf16 v[100:103], v[112:115], v[112:115], v[100:103]
    ds_read_b128 v[248:251], v25 offset:29696
    v_mfma_f32_16x16x32_bf16 v[32:35], v[152:155], v[116:119], v[32:35]
    s_add_u32 s41, s41, 30720
    v_mfma_f32_16x16x32_bf16 v[36:39], v[152:155], v[120:123], v[36:39]
    v_mfma_f32_16x16x32_bf16 v[40:43], v[156:159], v[116:119], v[40:43]
    s_cmp_eq_u32 s41, 94208
    v_mfma_f32_16x16x32_bf16 v[44:47], v[156:159], v[120:123], v[44:47]
    v_mfma_f32_16x16x32_bf16 v[48:51], v[160:163], v[116:119], v[48:51]
    v_mfma_f32_16x16x32_bf16 v[52:55], v[160:163], v[120:123], v[52:55]
    s_cselect_b32 s41, 2048, s41
    v_mfma_f32_16x16x32_bf16 v[56:59], v[164:167], v[116:119], v[56:59]
    v_mfma_f32_16x16x32_bf16 v[60:63], v[164:167], v[120:123], v[60:63]
    v_add_u32 v23, s41, v20
    v_mfma_f32_16x16x32_bf16 v[64:67], v[168:171], v[116:119], v[64:67]
    v_mfma_f32_16x16x32_bf16 v[68:71], v[168:171], v[120:123], v[68:71]
    v_mfma_f32_16x16x32_bf16 v[72:75], v[172:175], v[116:119], v[72:75]
    v_add_u32 v24, s41, v21
    v_mfma_f32_16x16x32_bf16 v[76:79], v[172:175], v[120:123], v[76:79]
    v_mfma_f32_16x16x32_bf16 v[80:83], v[176:179], v[116:119], v[80:83]
    v_add_u32 v25, s41, v8
    v_mfma_f32_16x16x32_bf16 v[84:87], v[176:179], v[120:123], v[84:87]
    v_mfma_f32_16x16x32_bf16 v[88:91], v[104:107], v[116:119], v[88:91]
    v_mfma_f32_16x16x32_bf16 v[96:99], v[116:119], v[116:119], v[96:99]
    s_add_u32 s42, s42, 1
    v_mfma_f32_16x16x32_bf16 v[92:95], v[104:107], v[120:123], v[92:95]
    v_mfma_f32_16x16x32_bf16 v[100:103], v[120:123], v[120:123], v[100:103]
    s_waitcnt lgkmcnt(0)
    s_barrier
    v_mfma_f32_16x16x32_bf16 v[32:35], v[196:199], v[180:183], v[32:35]
    ds_read_b64_tr_b16 v[108:109], v23 offset:0
    ds_read_b64_tr_b16 v[110:111], v23 offset:4096
    v_mfma_f32_16x16x32_bf16 v[36:39], v[196:199], v[184:187], v[36:39]
    ds_read_b64_tr_b16 v[112:113], v24 offset:0
    v_mfma_f32_16x16x32_bf16 v[40:43], v[200:203], v[180:183], v[40:43]
    ds_read_b64_tr_b16 v[114:115], v24 offset:4096
    v_mfma_f32_16x16x32_bf16 v[44:47], v[200:203], v[184:187], v[44:47]
    ds_read_b128 v[124:127], v25 offset:16384
    v_mfma_f32_16x16x32_bf16 v[48:51], v[204:207], v[180:183], v[48:51]
    ds_read_b128 v[128:131], v25 offset:18432
    ds_read_b128 v[132:135], v25 offset:20480
    v_mfma_f32_16x16x32_bf16 v[52:55], v[204:207], v[184:187], v[52:55]
    ds_read_b128 v[136:139], v25 offset:22528
    v_mfma_f32_16x16x32_bf16 v[56:59], v[208:211], v[180:183], v[56:59]
    ds_read_b128 v[140:143], v25 offset:24576
    v_mfma_f32_16x16x32_bf16 v[60:63], v[208:211], v[184:187], v[60:63]
    ds_read_b128 v[144:147], v25 offset:26624
    v_mfma_f32_16x16x32_bf16 v[64:67], v[212:215], v[180:183], v[64:67]
    ds_read_b128 v[148:151], v25 offset:28672
    v_mfma_f32_16x16x32_bf16 v[68:71], v[212:215], v[184:187], v[68:71]
    ds_read_b64_tr_b16 v[116:117], v23 offset:8192
    ds_read_b64_tr_b16 v[118:119], v23 offset:12288
    v_mfma_f32_16x16x32_bf16 v[72:75], v[216:219], v[180:183], v[72:75]
    ds_read_b64_tr_b16 v[120:121], v24 offset:8192
    v_mfma_f32_16x16x32_bf16 v[76:79], v[216:219], v[184:187], v[76:79]
    ds_read_b64_tr_b16 v[122:123], v24 offset:12288
    v_mfma_f32_16x16x32_bf16 v[80:83], v[220:223], v[180:183], v[80:83]
    ds_read_b128 v[152:155], v25 offset:17408
    v_mfma_f32_16x16x32_bf16 v[84:87], v[220:223], v[184:187], v[84:87]
    ds_read_b128 v[156:159], v25 offset:19456
    ds_read_b128 v[160:163], v25 offset:21504
    v_mfma_f32_16x16x32_bf16 v[88:91], v[104:107], v[180:183], v[88:91]
    ds_read_b128 v[164:167], v25 offset:23552
    v_mfma_f32_16x16x32_bf16 v[96:99], v[180:183], v[180:183], v[96:99]
    ds_read_b128 v[168:171], v25 offset:25600
    v_mfma_f32_16x16x32_bf16 v[92:95], v[104:107], v[184:187], v[92:95]
    ds_read_b128 v[172:175], v25 offset:27648
    v_mfma_f32_16x16x32_bf16 v[100:103], v[184:187], v[184:187], v[100:103]
    ds_read_b128 v[176:179], v25 offset:29696
    v_mfma_f32_16x16x32_bf16 v[32:35], v[224:227], v[188:191], v[32:35]
    s_add_u32 s41, s41, 30720
    v_mfma_f32_16x16x32_bf16 v[36:39], v[224:227], v[192:195], v[36:39]
    v_mfma_f32_16x16x32_bf16 v[40:43], v[228:231], v[188:191], v[40:43]
    s_cmp_eq_u32 s41, 94208
    v_mfma_f32_16x16x32_bf16 v[44:47], v[228:231], v[192:195], v[44:47]
    v_mfma_f32_16x16x32_bf16 v[48:51], v[232:235], v[188:191], v[48:51]
    v_mfma_f32_16x16x32_bf16 v[52:55], v[232:235], v[192:195], v[52:55]
    s_cselect_b32 s41, 2048, s41
    v_mfma_f32_16x16x32_bf16 v[56:59], v[236:239], v[188:191], v[56:59]
    v_mfma_f32_16x16x32_bf16 v[60:63], v[236:239], v[192:195], v[60:63]
    v_add_u32 v23, s41, v20
    v_mfma_f32_16x16x32_bf16 v[64:67], v[240:243], v[188:191], v[64:67]
    v_mfma_f32_16x16x32_bf16 v[68:71], v[240:243], v[192:195], v[68:71]
    v_mfma_f32_16x16x32_bf16 v[72:75], v[244:247], v[188:191], v[72:75]
    v_add_u32 v24, s41, v21
    v_mfma_f32_16x16x32_bf16 v[76:79], v[244:247], v[192:195], v[76:79]
    v_mfma_f32_16x16x32_bf16 v[80:83], v[248:251], v[188:191], v[80:83]
    v_add_u32 v25, s41, v8
    v_mfma_f32_16x16x32_bf16 v[84:87], v[248:251], v[192:195], v[84:87]
    v_mfma_f32_16x16x32_bf16 v[88:91], v[104:107], v[188:191], v[88:91]
    v_mfma_f32_16x16x32_bf16 v[96:99], v[188:191], v[188:191], v[96:99]
    s_add_u32 s42, s42, 1
    v_mfma_f32_16x16x32_bf16 v[92:95], v[104:107], v[192:195], v[92:95]
    v_mfma_f32_16x16x32_bf16 v[100:103], v[192:195], v[192:195], v[100:103]
    s_cmp_lt_u32 s42, 10
    s_cbranch_scc1 MC_loop
    v_lshlrev_b32 v30, 4, v4
    v_lshrrev_b32 v5, 2, v3
    v_lshl_add_u32 v5, v5, 4, v3
    v_lshlrev_b32 v5, 2, v5
    v_and_b32 v6, 3, v3
    v_cmp_eq_u32 s[56:57], 1, v6
    v_cmp_eq_u32 s[58:59], 2, v6
    v_cmp_eq_u32 vcc, 3, v6
    s_waitcnt lgkmcnt(0)
    ds_read_b128 v[108:111], v30 offset:0
    ds_read_b128 v[112:115], v30 offset:64
    ds_read_b128 v[116:119], v30 offset:128
    ds_read_b128 v[120:123], v30 offset:192
    ds_read_b128 v[124:127], v30 offset:256
    ds_read_b128 v[128:131], v30 offset:320
    ds_read_b128 v[132:135], v30 offset:384
    v_cndmask_b32 v96, v96, v97, s[56:57]
    v_cndmask_b32 v98, v98, v99, vcc
    v_cndmask_b32 v100, v100, v101, s[56:57]
    v_cndmask_b32 v102, v102, v103, vcc
    s_or_b64 s[58:59], s[58:59], vcc
    v_cndmask_b32 v96, v96, v98, s[58:59]
    ds_bpermute_b32 v96, v5, v96
    v_cndmask_b32 v100, v100, v102, s[58:59]
    ds_bpermute_b32 v100, v5, v100
    v_mov_b32 v26, 0xc0135761
    v_mov_b32 v28, 0xbdd2d3e8
    s_and_b32 s56, s11, 1
    s_lshr_b32 s57, s11, 1
    s_waitcnt lgkmcnt(0)
    v_mul_f32 v88, 0x3acccccd, v88
    v_mul_f32 v96, 0x3acccccd, v96
    v_mul_f32 v92, 0x3acccccd, v92
    v_mul_f32 v100, 0x3acccccd, v100
    v_fma_f32 v96, -v88, v88, v96
    v_fma_f32 v100, -v92, v92, v100
    v_max_f32 v96, 0, v96
    v_max_f32 v100, 0, v100
    v_cvt_pk_bf16_f32 v96, v96, v96
    v_lshlrev_b32 v96, 16, v96
    v_cvt_pk_bf16_f32 v100, v100, v100
    v_lshlrev_b32 v100, 16, v100
    v_add_f32 v96, 0x3727c5ac, v96
    v_add_f32 v100, 0x3727c5ac, v100
    v_cvt_pk_bf16_f32 v96, v96, v96
    v_lshlrev_b32 v96, 16, v96
    v_cvt_pk_bf16_f32 v100, v100, v100
    v_lshlrev_b32 v100, 16, v100
    v_sqrt_f32 v96, v96
    v_sqrt_f32 v100, v100
    v_cvt_pk_bf16_f32 v88, v88, v88
    v_lshlrev_b32 v88, 16, v88
    v_cvt_pk_bf16_f32 v92, v92, v92
    v_lshlrev_b32 v92, 16, v92
    v_cvt_pk_bf16_f32 v96, v96, v96
    v_lshlrev_b32 v96, 16, v96
    v_cvt_pk_bf16_f32 v100, v100, v100
    v_lshlrev_b32 v100, 16, v100
    v_rcp_f32 v96, v96
    v_rcp_f32 v100, v100
    v_pk_fma_f32 v[32:33], v[108:109], v[88:89], v[32:33] op_sel:[0,0,0] op_sel_hi:[1,0,1] neg_lo:[0,1,0] neg_hi:[0,1,0]
    v_pk_fma_f32 v[34:35], v[110:111], v[88:89], v[34:35] op_sel:[0,0,0] op_sel_hi:[1,0,1] neg_lo:[0,1,0] neg_hi:[0,1,0]
    v_pk_fma_f32 v[36:37], v[108:109], v[92:93], v[36:37] op_sel:[0,0,0] op_sel_hi:[1,0,1] neg_lo:[0,1,0] neg_hi:[0,1,0]
    v_pk_fma_f32 v[38:39], v[110:111], v[92:93], v[38:39] op_sel:[0,0,0] op_sel_hi:[1,0,1] neg_lo:[0,1,0] neg_hi:[0,1,0]
    v_pk_mul_f32 v[32:33], v[32:33], v[96:97] op_sel:[0,0] op_sel_hi:[1,0]
    v_pk_mul_f32 v[34:35], v[34:35], v[96:97] op_sel:[0,0] op_sel_hi:[1,0]
    v_pk_mul_f32 v[36:37], v[36:37], v[100:101] op_sel:[0,0] op_sel_hi:[1,0]
    v_pk_mul_f32 v[38:39], v[38:39], v[100:101] op_sel:[0,0] op_sel_hi:[1,0]
    v_pk_mul_f32 v[172:173], v[32:33], v[32:33]
    v_pk_mul_f32 v[174:175], v[34:35], v[34:35]
    v_pk_mul_f32 v[176:177], v[36:37], v[36:37]
    v_pk_mul_f32 v[178:179], v[38:39], v[38:39]
    v_pk_fma_f32 v[172:173], v[172:173], v[28:29], v[26:27] op_sel:[0,0,0] op_sel_hi:[1,0,0]
    v_pk_fma_f32 v[174:175], v[174:175], v[28:29], v[26:27] op_sel:[0,0,0] op_sel_hi:[1,0,0]
    v_pk_fma_f32 v[176:177], v[176:177], v[28:29], v[26:27] op_sel:[0,0,0] op_sel_hi:[1,0,0]
    v_pk_fma_f32 v[178:179], v[178:179], v[28:29], v[26:27] op_sel:[0,0,0] op_sel_hi:[1,0,0]
    v_pk_mul_f32 v[172:173], v[172:173], v[32:33]
    v_pk_mul_f32 v[174:175], v[174:175], v[34:35]
    v_pk_mul_f32 v[176:177], v[176:177], v[36:37]
    v_pk_mul_f32 v[178:179], v[178:179], v[38:39]
    v_exp_f32 v172, v172
    v_exp_f32 v173, v173
    v_exp_f32 v174, v174
    v_exp_f32 v175, v175
    v_exp_f32 v176, v176
    v_exp_f32 v177, v177
    v_exp_f32 v178, v178
    v_exp_f32 v179, v179
    v_pk_add_f32 v[172:173], v[172:173], 1.0 op_sel_hi:[1,0]
    v_pk_add_f32 v[174:175], v[174:175], 1.0 op_sel_hi:[1,0]
    v_pk_add_f32 v[176:177], v[176:177], 1.0 op_sel_hi:[1,0]
    v_pk_add_f32 v[178:179], v[178:179], 1.0 op_sel_hi:[1,0]
    v_rcp_f32 v172, v172
    v_rcp_f32 v173, v173
    v_rcp_f32 v174, v174
    v_rcp_f32 v175, v175
    v_rcp_f32 v176, v176
    v_rcp_f32 v177, v177
    v_rcp_f32 v178, v178
    v_rcp_f32 v179, v179
    v_pk_mul_f32 v[172:173], v[172:173], v[32:33]
    v_pk_mul_f32 v[174:175], v[174:175], v[34:35]
    v_pk_mul_f32 v[176:177], v[176:177], v[36:37]
    v_pk_mul_f32 v[178:179], v[178:179], v[38:39]
    v_cvt_pk_bf16_f32 v136, v172, v173
    v_cvt_pk_bf16_f32 v137, v174, v175
    v_cvt_pk_bf16_f32 v138, v176, v177
    v_cvt_pk_bf16_f32 v139, v178, v179
    v_dot2_f32_bf16 v180, v136, s52, 0
    v_dot2_f32_bf16 v181, v136, v136, 0
    v_dot2_f32_bf16 v182, v138, s52, 0
    v_dot2_f32_bf16 v183, v138, v138, 0
    v_dot2_f32_bf16 v180, v137, s52, v180
    v_dot2_f32_bf16 v181, v137, v137, v181
    v_dot2_f32_bf16 v182, v139, s52, v182
    v_dot2_f32_bf16 v183, v139, v139, v183
    v_pk_fma_f32 v[40:41], v[112:113], v[88:89], v[40:41] op_sel:[0,0,0] op_sel_hi:[1,0,1] neg_lo:[0,1,0] neg_hi:[0,1,0]
    v_pk_fma_f32 v[42:43], v[114:115], v[88:89], v[42:43] op_sel:[0,0,0] op_sel_hi:[1,0,1] neg_lo:[0,1,0] neg_hi:[0,1,0]
    v_pk_fma_f32 v[44:45], v[112:113], v[92:93], v[44:45] op_sel:[0,0,0] op_sel_hi:[1,0,1] neg_lo:[0,1,0] neg_hi:[0,1,0]
    v_pk_fma_f32 v[46:47], v[114:115], v[92:93], v[46:47] op_sel:[0,0,0] op_sel_hi:[1,0,1] neg_lo:[0,1,0] neg_hi:[0,1,0]
    v_pk_mul_f32 v[40:41], v[40:41], v[96:97] op_sel:[0,0] op_sel_hi:[1,0]
    v_pk_mul_f32 v[42:43], v[42:43], v[96:97] op_sel:[0,0] op_sel_hi:[1,0]
    v_pk_mul_f32 v[44:45], v[44:45], v[100:101] op_sel:[0,0] op_sel_hi:[1,0]
    v_pk_mul_f32 v[46:47], v[46:47], v[100:101] op_sel:[0,0] op_sel_hi:[1,0]
    v_pk_mul_f32 v[172:173], v[40:41], v[40:41]
    v_pk_mul_f32 v[174:175], v[42:43], v[42:43]
    v_pk_mul_f32 v[176:177], v[44:45], v[44:45]
    v_pk_mul_f32 v[178:179], v[46:47], v[46:47]
    v_pk_fma_f32 v[172:173], v[172:173], v[28:29], v[26:27] op_sel:[0,0,0] op_sel_hi:[1,0,0]
    v_pk_fma_f32 v[174:175], v[174:175], v[28:29], v[26:27] op_sel:[0,0,0] op_sel_hi:[1,0,0]
    v_pk_fma_f32 v[176:177], v[176:177], v[28:29], v[26:27] op_sel:[0,0,0] op_sel_hi:[1,0,0]
    v_pk_fma_f32 v[178:179], v[178:179], v[28:29], v[26:27] op_sel:[0,0,0] op_sel_hi:[1,0,0]
    v_pk_mul_f32 v[172:173], v[172:173], v[40:41]
    v_pk_mul_f32 v[174:175], v[174:175], v[42:43]
    v_pk_mul_f32 v[176:177], v[176:177], v[44:45]
    v_pk_mul_f32 v[178:179], v[178:179], v[46:47]
    v_exp_f32 v172, v172
    v_exp_f32 v173, v173
    v_exp_f32 v174, v174
    v_exp_f32 v175, v175
    v_exp_f32 v176, v176
    v_exp_f32 v177, v177
    v_exp_f32 v178, v178
    v_exp_f32 v179, v179
    v_pk_add_f32 v[172:173], v[172:173], 1.0 op_sel_hi:[1,0]
    v_pk_add_f32 v[174:175], v[174:175], 1.0 op_sel_hi:[1,0]
    v_pk_add_f32 v[176:177], v[176:177], 1.0 op_sel_hi:[1,0]
    v_pk_add_f32 v[178:179], v[178:179], 1.0 op_sel_hi:[1,0]
    v_rcp_f32 v172, v172
    v_rcp_f32 v173, v173
    v_rcp_f32 v174, v174
    v_rcp_f32 v175, v175
    v_rcp_f32 v176, v176
    v_rcp_f32 v177, v177
    v_rcp_f32 v178, v178
    v_rcp_f32 v179, v179
    v_pk_mul_f32 v[172:173], v[172:173], v[40:41]
    v_pk_mul_f32 v[174:175], v[174:175], v[42:43]
    v_pk_mul_f32 v[176:177], v[176:177], v[44:45]
    v_pk_mul_f32 v[178:179], v[178:179], v[46:47]
    v_cvt_pk_bf16_f32 v140, v172, v173
    v_cvt_pk_bf16_f32 v141, v174, v175
    v_cvt_pk_bf16_f32 v142, v176, v177
    v_cvt_pk_bf16_f32 v143, v178, v179
    v_dot2_f32_bf16 v180, v140, s52, v180
    v_dot2_f32_bf16 v181, v140, v140, v181
    v_dot2_f32_bf16 v182, v142, s52, v182
    v_dot2_f32_bf16 v183, v142, v142, v183
    v_dot2_f32_bf16 v180, v141, s52, v180
    v_dot2_f32_bf16 v181, v141, v141, v181
    v_dot2_f32_bf16 v182, v143, s52, v182
    v_dot2_f32_bf16 v183, v143, v143, v183
    v_pk_fma_f32 v[48:49], v[116:117], v[88:89], v[48:49] op_sel:[0,0,0] op_sel_hi:[1,0,1] neg_lo:[0,1,0] neg_hi:[0,1,0]
    v_pk_fma_f32 v[50:51], v[118:119], v[88:89], v[50:51] op_sel:[0,0,0] op_sel_hi:[1,0,1] neg_lo:[0,1,0] neg_hi:[0,1,0]
    v_pk_fma_f32 v[52:53], v[116:117], v[92:93], v[52:53] op_sel:[0,0,0] op_sel_hi:[1,0,1] neg_lo:[0,1,0] neg_hi:[0,1,0]
    v_pk_fma_f32 v[54:55], v[118:119], v[92:93], v[54:55] op_sel:[0,0,0] op_sel_hi:[1,0,1] neg_lo:[0,1,0] neg_hi:[0,1,0]
    v_pk_mul_f32 v[48:49], v[48:49], v[96:97] op_sel:[0,0] op_sel_hi:[1,0]
    v_pk_mul_f32 v[50:51], v[50:51], v[96:97] op_sel:[0,0] op_sel_hi:[1,0]
    v_pk_mul_f32 v[52:53], v[52:53], v[100:101] op_sel:[0,0] op_sel_hi:[1,0]
    v_pk_mul_f32 v[54:55], v[54:55], v[100:101] op_sel:[0,0] op_sel_hi:[1,0]
    v_pk_mul_f32 v[172:173], v[48:49], v[48:49]
    v_pk_mul_f32 v[174:175], v[50:51], v[50:51]
    v_pk_mul_f32 v[176:177], v[52:53], v[52:53]
    v_pk_mul_f32 v[178:179], v[54:55], v[54:55]
    v_pk_fma_f32 v[172:173], v[172:173], v[28:29], v[26:27] op_sel:[0,0,0] op_sel_hi:[1,0,0]
    v_pk_fma_f32 v[174:175], v[174:175], v[28:29], v[26:27] op_sel:[0,0,0] op_sel_hi:[1,0,0]
    v_pk_fma_f32 v[176:177], v[176:177], v[28:29], v[26:27] op_sel:[0,0,0] op_sel_hi:[1,0,0]
    v_pk_fma_f32 v[178:179], v[178:179], v[28:29], v[26:27] op_sel:[0,0,0] op_sel_hi:[1,0,0]
    v_pk_mul_f32 v[172:173], v[172:173], v[48:49]
    v_pk_mul_f32 v[174:175], v[174:175], v[50:51]
    v_pk_mul_f32 v[176:177], v[176:177], v[52:53]
    v_pk_mul_f32 v[178:179], v[178:179], v[54:55]
    v_exp_f32 v172, v172
    v_exp_f32 v173, v173
    v_exp_f32 v174, v174
    v_exp_f32 v175, v175
    v_exp_f32 v176, v176
    v_exp_f32 v177, v177
    v_exp_f32 v178, v178
    v_exp_f32 v179, v179
    v_pk_add_f32 v[172:173], v[172:173], 1.0 op_sel_hi:[1,0]
    v_pk_add_f32 v[174:175], v[174:175], 1.0 op_sel_hi:[1,0]
    v_pk_add_f32 v[176:177], v[176:177], 1.0 op_sel_hi:[1,0]
    v_pk_add_f32 v[178:179], v[178:179], 1.0 op_sel_hi:[1,0]
    v_rcp_f32 v172, v172
    v_rcp_f32 v173, v173
    v_rcp_f32 v174, v174
    v_rcp_f32 v175, v175
    v_rcp_f32 v176, v176
    v_rcp_f32 v177, v177
    v_rcp_f32 v178, v178
    v_rcp_f32 v179, v179
    v_pk_mul_f32 v[172:173], v[172:173], v[48:49]
    v_pk_mul_f32 v[174:175], v[174:175], v[50:51]
    v_pk_mul_f32 v[176:177], v[176:177], v[52:53]
    v_pk_mul_f32 v[178:179], v[178:179], v[54:55]
    v_cvt_pk_bf16_f32 v144, v172, v173
    v_cvt_pk_bf16_f32 v145, v174, v175
    v_cvt_pk_bf16_f32 v146, v176, v177
    v_cvt_pk_bf16_f32 v147, v178, v179
    v_dot2_f32_bf16 v180, v144, s52, v180
    v_dot2_f32_bf16 v181, v144, v144, v181
    v_dot2_f32_bf16 v182, v146, s52, v182
    v_dot2_f32_bf16 v183, v146, v146, v183
    v_dot2_f32_bf16 v180, v145, s52, v180
    v_dot2_f32_bf16 v181, v145, v145, v181
    v_dot2_f32_bf16 v182, v147, s52, v182
    v_dot2_f32_bf16 v183, v147, v147, v183
    s_cmp_eq_u32 s56, 1
    s_cbranch_scc1 MC_s3
    v_pk_fma_f32 v[56:57], v[120:121], v[88:89], v[56:57] op_sel:[0,0,0] op_sel_hi:[1,0,1] neg_lo:[0,1,0] neg_hi:[0,1,0]
    v_pk_fma_f32 v[58:59], v[122:123], v[88:89], v[58:59] op_sel:[0,0,0] op_sel_hi:[1,0,1] neg_lo:[0,1,0] neg_hi:[0,1,0]
    v_pk_fma_f32 v[60:61], v[120:121], v[92:93], v[60:61] op_sel:[0,0,0] op_sel_hi:[1,0,1] neg_lo:[0,1,0] neg_hi:[0,1,0]
    v_pk_fma_f32 v[62:63], v[122:123], v[92:93], v[62:63] op_sel:[0,0,0] op_sel_hi:[1,0,1] neg_lo:[0,1,0] neg_hi:[0,1,0]
    v_pk_mul_f32 v[56:57], v[56:57], v[96:97] op_sel:[0,0] op_sel_hi:[1,0]
    v_pk_mul_f32 v[58:59], v[58:59], v[96:97] op_sel:[0,0] op_sel_hi:[1,0]
    v_pk_mul_f32 v[60:61], v[60:61], v[100:101] op_sel:[0,0] op_sel_hi:[1,0]
    v_pk_mul_f32 v[62:63], v[62:63], v[100:101] op_sel:[0,0] op_sel_hi:[1,0]
    v_pk_mul_f32 v[172:173], v[56:57], v[56:57]
    v_pk_mul_f32 v[174:175], v[58:59], v[58:59]
    v_pk_mul_f32 v[176:177], v[60:61], v[60:61]
    v_pk_mul_f32 v[178:179], v[62:63], v[62:63]
    v_pk_fma_f32 v[172:173], v[172:173], v[28:29], v[26:27] op_sel:[0,0,0] op_sel_hi:[1,0,0]
    v_pk_fma_f32 v[174:175], v[174:175], v[28:29], v[26:27] op_sel:[0,0,0] op_sel_hi:[1,0,0]
    v_pk_fma_f32 v[176:177], v[176:177], v[28:29], v[26:27] op_sel:[0,0,0] op_sel_hi:[1,0,0]
    v_pk_fma_f32 v[178:179], v[178:179], v[28:29], v[26:27] op_sel:[0,0,0] op_sel_hi:[1,0,0]
    v_pk_mul_f32 v[172:173], v[172:173], v[56:57]
    v_pk_mul_f32 v[174:175], v[174:175], v[58:59]
    v_pk_mul_f32 v[176:177], v[176:177], v[60:61]
    v_pk_mul_f32 v[178:179], v[178:179], v[62:63]
    v_exp_f32 v172, v172
    v_exp_f32 v173, v173
    v_exp_f32 v174, v174
    v_exp_f32 v175, v175
    v_exp_f32 v176, v176
    v_exp_f32 v177, v177
    v_exp_f32 v178, v178
    v_exp_f32 v179, v179
    v_pk_add_f32 v[172:173], v[172:173], 1.0 op_sel_hi:[1,0]
    v_pk_add_f32 v[174:175], v[174:175], 1.0 op_sel_hi:[1,0]
    v_pk_add_f32 v[176:177], v[176:177], 1.0 op_sel_hi:[1,0]
    v_pk_add_f32 v[178:179], v[178:179], 1.0 op_sel_hi:[1,0]
    v_rcp_f32 v172, v172
    v_rcp_f32 v173, v173
    v_rcp_f32 v174, v174
    v_rcp_f32 v175, v175
    v_rcp_f32 v176, v176
    v_rcp_f32 v177, v177
    v_rcp_f32 v178, v178
    v_rcp_f32 v179, v179
    v_pk_mul_f32 v[172:173], v[172:173], v[56:57]
    v_pk_mul_f32 v[174:175], v[174:175], v[58:59]
    v_pk_mul_f32 v[176:177], v[176:177], v[60:61]
    v_pk_mul_f32 v[178:179], v[178:179], v[62:63]
    v_cvt_pk_bf16_f32 v148, v172, v173
    v_cvt_pk_bf16_f32 v149, v174, v175
    v_cvt_pk_bf16_f32 v150, v176, v177
    v_cvt_pk_bf16_f32 v151, v178, v179
    v_dot2_f32_bf16 v180, v148, s52, v180
    v_dot2_f32_bf16 v181, v148, v148, v181
    v_dot2_f32_bf16 v182, v150, s52, v182
    v_dot2_f32_bf16 v183, v150, v150, v183
    v_dot2_f32_bf16 v180, v149, s52, v180
    v_dot2_f32_bf16 v181, v149, v149, v181
    v_dot2_f32_bf16 v182, v151, s52, v182
    v_dot2_f32_bf16 v183, v151, v151, v183
MC_s3:
    v_mov_b32 v184, v180
    v_mov_b32 v185, v181
    v_mov_b32 v186, v182
    v_mov_b32 v187, v183
    v_permlane16_swap_b32 v180, v184
    v_permlane16_swap_b32 v181, v185
    v_permlane16_swap_b32 v182, v186
    v_permlane16_swap_b32 v183, v187
    v_add_f32 v180, v180, v184
    v_add_f32 v181, v181, v185
    v_add_f32 v182, v182, v186
    v_add_f32 v183, v183, v187
    v_mov_b32 v184, v180
    v_mov_b32 v185, v181
    v_mov_b32 v186, v182
    v_mov_b32 v187, v183
    v_permlane32_swap_b32 v180, v184
    v_permlane32_swap_b32 v181, v185
    v_permlane32_swap_b32 v182, v186
    v_permlane32_swap_b32 v183, v187
    v_add_f32 v180, v180, v184
    v_add_f32 v181, v181, v185
    v_add_f32 v182, v182, v186
    v_add_f32 v183, v183, v187
    s_add_u32 s16, s6, 7929856
    s_addc_u32 s17, s7, 0
    s_mov_b32 s18, 262144
    s_mov_b32 s19, 0x00020000
    v_cmp_eq_u32 vcc, 0, v4
    v_max_f32 v181, 0, v181
    v_max_f32 v183, 0, v183
    v_cndmask_b32 v184, v182, v180, vcc
    v_cndmask_b32 v185, v183, v181, vcc
    v_lshlrev_b32 v5, 3, v1
    s_lshl_b32 s59, s53, 11
    s_lshl_b32 s49, s11, 8
    s_add_u32 s49, s49, s59
    s_mov_b64 exec, 0xffffffff
    buffer_store_dwordx2 v[184:185], v5, s[16:19], s49 offen sc1
    s_mov_b64 exec, -1
    s_barrier
    v_lshlrev_b32 v9, 3, v1
    s_cmp_eq_u32 s56, 0
    s_cbranch_scc1 MC_z1b
    v_pk_fma_f32 v[56:57], v[120:121], v[88:89], v[56:57] op_sel:[0,0,0] op_sel_hi:[1,0,1] neg_lo:[0,1,0] neg_hi:[0,1,0]
    v_pk_fma_f32 v[58:59], v[122:123], v[88:89], v[58:59] op_sel:[0,0,0] op_sel_hi:[1,0,1] neg_lo:[0,1,0] neg_hi:[0,1,0]
    v_pk_fma_f32 v[60:61], v[120:121], v[92:93], v[60:61] op_sel:[0,0,0] op_sel_hi:[1,0,1] neg_lo:[0,1,0] neg_hi:[0,1,0]
    v_pk_fma_f32 v[62:63], v[122:123], v[92:93], v[62:63] op_sel:[0,0,0] op_sel_hi:[1,0,1] neg_lo:[0,1,0] neg_hi:[0,1,0]
    v_pk_mul_f32 v[56:57], v[56:57], v[96:97] op_sel:[0,0] op_sel_hi:[1,0]
    v_pk_mul_f32 v[58:59], v[58:59], v[96:97] op_sel:[0,0] op_sel_hi:[1,0]
    v_pk_mul_f32 v[60:61], v[60:61], v[100:101] op_sel:[0,0] op_sel_hi:[1,0]
    v_pk_mul_f32 v[62:63], v[62:63], v[100:101] op_sel:[0,0] op_sel_hi:[1,0]
    v_pk_mul_f32 v[172:173], v[56:57], v[56:57]
    v_pk_mul_f32 v[174:175], v[58:59], v[58:59]
    v_pk_mul_f32 v[176:177], v[60:61], v[60:61]
    v_pk_mul_f32 v[178:179], v[62:63], v[62:63]
    v_pk_fma_f32 v[172:173], v[172:173], v[28:29], v[26:27] op_sel:[0,0,0] op_sel_hi:[1,0,0]
    v_pk_fma_f32 v[174:175], v[174:175], v[28:29], v[26:27] op_sel:[0,0,0] op_sel_hi:[1,0,0]
    v_pk_fma_f32 v[176:177], v[176:177], v[28:29], v[26:27] op_sel:[0,0,0] op_sel_hi:[1,0,0]
    v_pk_fma_f32 v[178:179], v[178:179], v[28:29], v[26:27] op_sel:[0,0,0] op_sel_hi:[1,0,0]
    v_pk_mul_f32 v[172:173], v[172:173], v[56:57]
    v_pk_mul_f32 v[174:175], v[174:175], v[58:59]
    v_pk_mul_f32 v[176:177], v[176:177], v[60:61]
    v_pk_mul_f32 v[178:179], v[178:179], v[62:63]
    v_exp_f32 v172, v172
    v_exp_f32 v173, v173
    v_exp_f32 v174, v174
    v_exp_f32 v175, v175
    v_exp_f32 v176, v176
    v_exp_f32 v177, v177
    v_exp_f32 v178, v178
    v_exp_f32 v179, v179
    v_pk_add_f32 v[172:173], v[172:173], 1.0 op_sel_hi:[1,0]
    v_pk_add_f32 v[174:175], v[174:175], 1.0 op_sel_hi:[1,0]
    v_pk_add_f32 v[176:177], v[176:177], 1.0 op_sel_hi:[1,0]
    v_pk_add_f32 v[178:179], v[178:179], 1.0 op_sel_hi:[1,0]
    v_rcp_f32 v172, v172
    v_rcp_f32 v173, v173
    v_rcp_f32 v174, v174
    v_rcp_f32 v175, v175
    v_rcp_f32 v176, v176
    v_rcp_f32 v177, v177
    v_rcp_f32 v178, v178
    v_rcp_f32 v179, v179
    v_pk_mul_f32 v[172:173], v[172:173], v[56:57]
    v_pk_mul_f32 v[174:175], v[174:175], v[58:59]
    v_pk_mul_f32 v[176:177], v[176:177], v[60:61]
    v_pk_mul_f32 v[178:179], v[178:179], v[62:63]
    v_cvt_pk_bf16_f32 v148, v172, v173
    v_cvt_pk_bf16_f32 v149, v174, v175
    v_cvt_pk_bf16_f32 v150, v176, v177
    v_cvt_pk_bf16_f32 v151, v178, v179
MC_z1b:
    v_pk_fma_f32 v[64:65], v[124:125], v[88:89], v[64:65] op_sel:[0,0,0] op_sel_hi:[1,0,1] neg_lo:[0,1,0] neg_hi:[0,1,0]
    v_pk_fma_f32 v[66:67], v[126:127], v[88:89], v[66:67] op_sel:[0,0,0] op_sel_hi:[1,0,1] neg_lo:[0,1,0] neg_hi:[0,1,0]
    v_pk_fma_f32 v[68:69], v[124:125], v[92:93], v[68:69] op_sel:[0,0,0] op_sel_hi:[1,0,1] neg_lo:[0,1,0] neg_hi:[0,1,0]
    v_pk_fma_f32 v[70:71], v[126:127], v[92:93], v[70:71] op_sel:[0,0,0] op_sel_hi:[1,0,1] neg_lo:[0,1,0] neg_hi:[0,1,0]
    v_pk_mul_f32 v[64:65], v[64:65], v[96:97] op_sel:[0,0] op_sel_hi:[1,0]
    v_pk_mul_f32 v[66:67], v[66:67], v[96:97] op_sel:[0,0] op_sel_hi:[1,0]
    v_pk_mul_f32 v[68:69], v[68:69], v[100:101] op_sel:[0,0] op_sel_hi:[1,0]
    v_pk_mul_f32 v[70:71], v[70:71], v[100:101] op_sel:[0,0] op_sel_hi:[1,0]
    v_pk_mul_f32 v[172:173], v[64:65], v[64:65]
    v_pk_mul_f32 v[174:175], v[66:67], v[66:67]
    v_pk_mul_f32 v[176:177], v[68:69], v[68:69]
    v_pk_mul_f32 v[178:179], v[70:71], v[70:71]
    v_pk_fma_f32 v[172:173], v[172:173], v[28:29], v[26:27] op_sel:[0,0,0] op_sel_hi:[1,0,0]
    v_pk_fma_f32 v[174:175], v[174:175], v[28:29], v[26:27] op_sel:[0,0,0] op_sel_hi:[1,0,0]
    v_pk_fma_f32 v[176:177], v[176:177], v[28:29], v[26:27] op_sel:[0,0,0] op_sel_hi:[1,0,0]
    v_pk_fma_f32 v[178:179], v[178:179], v[28:29], v[26:27] op_sel:[0,0,0] op_sel_hi:[1,0,0]
    v_pk_mul_f32 v[172:173], v[172:173], v[64:65]
    v_pk_mul_f32 v[174:175], v[174:175], v[66:67]
    v_pk_mul_f32 v[176:177], v[176:177], v[68:69]
    v_pk_mul_f32 v[178:179], v[178:179], v[70:71]
    v_exp_f32 v172, v172
    v_exp_f32 v173, v173
    v_exp_f32 v174, v174
    v_exp_f32 v175, v175
    v_exp_f32 v176, v176
    v_exp_f32 v177, v177
    v_exp_f32 v178, v178
    v_exp_f32 v179, v179
    v_pk_add_f32 v[172:173], v[172:173], 1.0 op_sel_hi:[1,0]
    v_pk_add_f32 v[174:175], v[174:175], 1.0 op_sel_hi:[1,0]
    v_pk_add_f32 v[176:177], v[176:177], 1.0 op_sel_hi:[1,0]
    v_pk_add_f32 v[178:179], v[178:179], 1.0 op_sel_hi:[1,0]
    v_rcp_f32 v172, v172
    v_rcp_f32 v173, v173
    v_rcp_f32 v174, v174
    v_rcp_f32 v175, v175
    v_rcp_f32 v176, v176
    v_rcp_f32 v177, v177
    v_rcp_f32 v178, v178
    v_rcp_f32 v179, v179
    v_pk_mul_f32 v[172:173], v[172:173], v[64:65]
    v_pk_mul_f32 v[174:175], v[174:175], v[66:67]
    v_pk_mul_f32 v[176:177], v[176:177], v[68:69]
    v_pk_mul_f32 v[178:179], v[178:179], v[70:71]
    v_cvt_pk_bf16_f32 v152, v172, v173
    v_cvt_pk_bf16_f32 v153, v174, v175
    v_cvt_pk_bf16_f32 v154, v176, v177
    v_cvt_pk_bf16_f32 v155, v178, v179
    v_pk_fma_f32 v[72:73], v[128:129], v[88:89], v[72:73] op_sel:[0,0,0] op_sel_hi:[1,0,1] neg_lo:[0,1,0] neg_hi:[0,1,0]
    v_pk_fma_f32 v[74:75], v[130:131], v[88:89], v[74:75] op_sel:[0,0,0] op_sel_hi:[1,0,1] neg_lo:[0,1,0] neg_hi:[0,1,0]
    v_pk_fma_f32 v[76:77], v[128:129], v[92:93], v[76:77] op_sel:[0,0,0] op_sel_hi:[1,0,1] neg_lo:[0,1,0] neg_hi:[0,1,0]
    v_pk_fma_f32 v[78:79], v[130:131], v[92:93], v[78:79] op_sel:[0,0,0] op_sel_hi:[1,0,1] neg_lo:[0,1,0] neg_hi:[0,1,0]
    v_pk_mul_f32 v[72:73], v[72:73], v[96:97] op_sel:[0,0] op_sel_hi:[1,0]
    v_pk_mul_f32 v[74:75], v[74:75], v[96:97] op_sel:[0,0] op_sel_hi:[1,0]
    v_pk_mul_f32 v[76:77], v[76:77], v[100:101] op_sel:[0,0] op_sel_hi:[1,0]
    v_pk_mul_f32 v[78:79], v[78:79], v[100:101] op_sel:[0,0] op_sel_hi:[1,0]
    v_pk_mul_f32 v[172:173], v[72:73], v[72:73]
    v_pk_mul_f32 v[174:175], v[74:75], v[74:75]
    v_pk_mul_f32 v[176:177], v[76:77], v[76:77]
    v_pk_mul_f32 v[178:179], v[78:79], v[78:79]
    v_pk_fma_f32 v[172:173], v[172:173], v[28:29], v[26:27] op_sel:[0,0,0] op_sel_hi:[1,0,0]
    v_pk_fma_f32 v[174:175], v[174:175], v[28:29], v[26:27] op_sel:[0,0,0] op_sel_hi:[1,0,0]
    v_pk_fma_f32 v[176:177], v[176:177], v[28:29], v[26:27] op_sel:[0,0,0] op_sel_hi:[1,0,0]
    v_pk_fma_f32 v[178:179], v[178:179], v[28:29], v[26:27] op_sel:[0,0,0] op_sel_hi:[1,0,0]
    v_pk_mul_f32 v[172:173], v[172:173], v[72:73]
    v_pk_mul_f32 v[174:175], v[174:175], v[74:75]
    v_pk_mul_f32 v[176:177], v[176:177], v[76:77]
    v_pk_mul_f32 v[178:179], v[178:179], v[78:79]
    v_exp_f32 v172, v172
    v_exp_f32 v173, v173
    v_exp_f32 v174, v174
    v_exp_f32 v175, v175
    v_exp_f32 v176, v176
    v_exp_f32 v177, v177
    v_exp_f32 v178, v178
    v_exp_f32 v179, v179
    v_pk_add_f32 v[172:173], v[172:173], 1.0 op_sel_hi:[1,0]
    v_pk_add_f32 v[174:175], v[174:175], 1.0 op_sel_hi:[1,0]
    v_pk_add_f32 v[176:177], v[176:177], 1.0 op_sel_hi:[1,0]
    v_pk_add_f32 v[178:179], v[178:179], 1.0 op_sel_hi:[1,0]
    v_rcp_f32 v172, v172
    v_rcp_f32 v173, v173
    v_rcp_f32 v174, v174
    v_rcp_f32 v175, v175
    v_rcp_f32 v176, v176
    v_rcp_f32 v177, v177
    v_rcp_f32 v178, v178
    v_rcp_f32 v179, v179
    v_pk_mul_f32 v[172:173], v[172:173], v[72:73]
    v_pk_mul_f32 v[174:175], v[174:175], v[74:75]
    v_pk_mul_f32 v[176:177], v[176:177], v[76:77]
    v_pk_mul_f32 v[178:179], v[178:179], v[78:79]
    v_cvt_pk_bf16_f32 v156, v172, v173
    v_cvt_pk_bf16_f32 v157, v174, v175
    v_cvt_pk_bf16_f32 v158, v176, v177
    v_cvt_pk_bf16_f32 v159, v178, v179
    v_pk_fma_f32 v[80:81], v[132:133], v[88:89], v[80:81] op_sel:[0,0,0] op_sel_hi:[1,0,1] neg_lo:[0,1,0] neg_hi:[0,1,0]
    v_pk_fma_f32 v[82:83], v[134:135], v[88:89], v[82:83] op_sel:[0,0,0] op_sel_hi:[1,0,1] neg_lo:[0,1,0] neg_hi:[0,1,0]
    v_pk_fma_f32 v[84:85], v[132:133], v[92:93], v[84:85] op_sel:[0,0,0] op_sel_hi:[1,0,1] neg_lo:[0,1,0] neg_hi:[0,1,0]
    v_pk_fma_f32 v[86:87], v[134:135], v[92:93], v[86:87] op_sel:[0,0,0] op_sel_hi:[1,0,1] neg_lo:[0,1,0] neg_hi:[0,1,0]
    v_pk_mul_f32 v[80:81], v[80:81], v[96:97] op_sel:[0,0] op_sel_hi:[1,0]
    v_pk_mul_f32 v[82:83], v[82:83], v[96:97] op_sel:[0,0] op_sel_hi:[1,0]
    v_pk_mul_f32 v[84:85], v[84:85], v[100:101] op_sel:[0,0] op_sel_hi:[1,0]
    v_pk_mul_f32 v[86:87], v[86:87], v[100:101] op_sel:[0,0] op_sel_hi:[1,0]
    v_pk_mul_f32 v[172:173], v[80:81], v[80:81]
    v_pk_mul_f32 v[174:175], v[82:83], v[82:83]
    v_pk_mul_f32 v[176:177], v[84:85], v[84:85]
    v_pk_mul_f32 v[178:179], v[86:87], v[86:87]
    v_pk_fma_f32 v[172:173], v[172:173], v[28:29], v[26:27] op_sel:[0,0,0] op_sel_hi:[1,0,0]
    v_pk_fma_f32 v[174:175], v[174:175], v[28:29], v[26:27] op_sel:[0,0,0] op_sel_hi:[1,0,0]
    v_pk_fma_f32 v[176:177], v[176:177], v[28:29], v[26:27] op_sel:[0,0,0] op_sel_hi:[1,0,0]
    v_pk_fma_f32 v[178:179], v[178:179], v[28:29], v[26:27] op_sel:[0,0,0] op_sel_hi:[1,0,0]
    v_pk_mul_f32 v[172:173], v[172:173], v[80:81]
    v_pk_mul_f32 v[174:175], v[174:175], v[82:83]
    v_pk_mul_f32 v[176:177], v[176:177], v[84:85]
    v_pk_mul_f32 v[178:179], v[178:179], v[86:87]
    v_exp_f32 v172, v172
    v_exp_f32 v173, v173
    v_exp_f32 v174, v174
    v_exp_f32 v175, v175
    v_exp_f32 v176, v176
    v_exp_f32 v177, v177
    v_exp_f32 v178, v178
    v_exp_f32 v179, v179
    v_pk_add_f32 v[172:173], v[172:173], 1.0 op_sel_hi:[1,0]
    v_pk_add_f32 v[174:175], v[174:175], 1.0 op_sel_hi:[1,0]
    v_pk_add_f32 v[176:177], v[176:177], 1.0 op_sel_hi:[1,0]
    v_pk_add_f32 v[178:179], v[178:179], 1.0 op_sel_hi:[1,0]
    v_rcp_f32 v172, v172
    v_rcp_f32 v173, v173
    v_rcp_f32 v174, v174
    v_rcp_f32 v175, v175
    v_rcp_f32 v176, v176
    v_rcp_f32 v177, v177
    v_rcp_f32 v178, v178
    v_rcp_f32 v179, v179
    v_pk_mul_f32 v[172:173], v[172:173], v[80:81]
    v_pk_mul_f32 v[174:175], v[174:175], v[82:83]
    v_pk_mul_f32 v[176:177], v[176:177], v[84:85]
    v_pk_mul_f32 v[178:179], v[178:179], v[86:87]
    v_cvt_pk_bf16_f32 v160, v172, v173
    v_cvt_pk_bf16_f32 v161, v174, v175
    v_cvt_pk_bf16_f32 v162, v176, v177
    v_cvt_pk_bf16_f32 v163, v178, v179
    v_mov_b32 v92, v148
    v_mov_b32 v93, v149
    v_mov_b32 v94, v150
    v_mov_b32 v95, v151
    v_mov_b32 v96, v152
    v_mov_b32 v97, v153
    v_mov_b32 v98, v154
    v_mov_b32 v99, v155
    v_mov_b32 v100, v156
    v_mov_b32 v101, v157
    v_mov_b32 v102, v158
    v_mov_b32 v103, v159
    v_mov_b32 v104, v160
    v_mov_b32 v105, v161
    v_mov_b32 v106, v162
    v_mov_b32 v107, v163
    s_mul_i32 s49, s3, 4352
    s_add_u32 s49, s49, 2048
    v_mul_u32_u24 v6, 136, v3
    v_lshl_add_u32 v6, v4, 3, v6
    v_add_u32 v6, s49, v6
    v_bfe_u32 v7, v1, 2, 4
    v_mul_u32_u24 v7, 136, v7
    v_and_b32 v5, 3, v1
    v_lshl_add_u32 v7, v5, 3, v7
    v_add_u32 v7, s49, v7
    s_lshl_b32 s58, s12, 7
    v_lshl_add_u32 v5, v3, 2, s58
    s_add_u32 s24, s6, 15269888
    s_addc_u32 s25, s7, 0
    s_mov_b32 s26, 3670016
    s_mov_b32 s27, 0x00020000
    s_lshl_b32 s59, s57, 5
    s_lshr_b32 s49, s53, 2
    s_add_u32 s59, s59, s49
    s_mul_i32 s59, s59, 14
    s_lshl_b32 s49, s56, 3
    s_add_u32 s59, s59, s49
    s_and_b32 s49, s12, 1
    s_add_u32 s59, s59, s49
    s_lshl_b32 s59, s59, 10
    v_lshlrev_b32 v32, 16, v136
    v_and_b32 v33, 0xffff0000, v136
    v_lshlrev_b32 v34, 16, v137
    v_and_b32 v35, 0xffff0000, v137
    v_lshlrev_b32 v36, 16, v138
    v_and_b32 v37, 0xffff0000, v138
    v_lshlrev_b32 v38, 16, v139
    v_and_b32 v39, 0xffff0000, v139
    v_lshlrev_b32 v40, 16, v140
    v_and_b32 v41, 0xffff0000, v140
    v_lshlrev_b32 v42, 16, v141
    v_and_b32 v43, 0xffff0000, v141
    v_lshlrev_b32 v44, 16, v142
    v_and_b32 v45, 0xffff0000, v142
    v_lshlrev_b32 v46, 16, v143
    v_and_b32 v47, 0xffff0000, v143
    v_lshlrev_b32 v48, 16, v144
    v_and_b32 v49, 0xffff0000, v144
    v_lshlrev_b32 v50, 16, v145
    v_and_b32 v51, 0xffff0000, v145
    v_lshlrev_b32 v52, 16, v146
    v_and_b32 v53, 0xffff0000, v146
    v_lshlrev_b32 v54, 16, v147
    v_and_b32 v55, 0xffff0000, v147
    v_lshlrev_b32 v56, 16, v148
    v_and_b32 v57, 0xffff0000, v148
    v_lshlrev_b32 v58, 16, v149
    v_and_b32 v59, 0xffff0000, v149
    v_lshlrev_b32 v60, 16, v150
    v_and_b32 v61, 0xffff0000, v150
    v_lshlrev_b32 v62, 16, v151
    v_and_b32 v63, 0xffff0000, v151
    s_barrier
    ds_read_b32 v88, v5 offset:512
    ds_read_b32 v89, v5 offset:1024
    ds_read_b32 v90, v5 offset:576
    ds_read_b32 v91, v5 offset:1088
    s_waitcnt lgkmcnt(0)
    v_pk_add_f32 v[32:33], v[32:33], v[88:89] op_sel:[0,0] op_sel_hi:[1,0] neg_lo:[0,1] neg_hi:[0,1]
    v_pk_add_f32 v[34:35], v[34:35], v[88:89] op_sel:[0,0] op_sel_hi:[1,0] neg_lo:[0,1] neg_hi:[0,1]
    v_pk_add_f32 v[36:37], v[36:37], v[90:91] op_sel:[0,0] op_sel_hi:[1,0] neg_lo:[0,1] neg_hi:[0,1]
    v_pk_add_f32 v[38:39], v[38:39], v[90:91] op_sel:[0,0] op_sel_hi:[1,0] neg_lo:[0,1] neg_hi:[0,1]
    v_pk_mul_f32 v[32:33], v[32:33], v[88:89] op_sel:[0,1] op_sel_hi:[1,1]
    v_pk_mul_f32 v[34:35], v[34:35], v[88:89] op_sel:[0,1] op_sel_hi:[1,1]
    v_pk_mul_f32 v[36:37], v[36:37], v[90:91] op_sel:[0,1] op_sel_hi:[1,1]
    v_pk_mul_f32 v[38:39], v[38:39], v[90:91] op_sel:[0,1] op_sel_hi:[1,1]
    v_cvt_pk_bf16_f32 v136, v32, v33
    v_cvt_pk_bf16_f32 v137, v34, v35
    v_cvt_pk_bf16_f32 v138, v36, v37
    v_cvt_pk_bf16_f32 v139, v38, v39
    ds_write_b64 v6, v[136:137] offset:0
    ds_write_b64 v6, v[138:139] offset:2176
    v_pk_add_f32 v[40:41], v[40:41], v[88:89] op_sel:[0,0] op_sel_hi:[1,0] neg_lo:[0,1] neg_hi:[0,1]
    v_pk_add_f32 v[42:43], v[42:43], v[88:89] op_sel:[0,0] op_sel_hi:[1,0] neg_lo:[0,1] neg_hi:[0,1]
    v_pk_add_f32 v[44:45], v[44:45], v[90:91] op_sel:[0,0] op_sel_hi:[1,0] neg_lo:[0,1] neg_hi:[0,1]
    v_pk_add_f32 v[46:47], v[46:47], v[90:91] op_sel:[0,0] op_sel_hi:[1,0] neg_lo:[0,1] neg_hi:[0,1]
    v_pk_mul_f32 v[40:41], v[40:41], v[88:89] op_sel:[0,1] op_sel_hi:[1,1]
    v_pk_mul_f32 v[42:43], v[42:43], v[88:89] op_sel:[0,1] op_sel_hi:[1,1]
    v_pk_mul_f32 v[44:45], v[44:45], v[90:91] op_sel:[0,1] op_sel_hi:[1,1]
    v_pk_mul_f32 v[46:47], v[46:47], v[90:91] op_sel:[0,1] op_sel_hi:[1,1]
    v_cvt_pk_bf16_f32 v140, v40, v41
    v_cvt_pk_bf16_f32 v141, v42, v43
    v_cvt_pk_bf16_f32 v142, v44, v45
    v_cvt_pk_bf16_f32 v143, v46, v47
    ds_write_b64 v6, v[140:141] offset:32
    ds_write_b64 v6, v[142:143] offset:2208
    v_pk_add_f32 v[48:49], v[48:49], v[88:89] op_sel:[0,0] op_sel_hi:[1,0] neg_lo:[0,1] neg_hi:[0,1]
    v_pk_add_f32 v[50:51], v[50:51], v[88:89] op_sel:[0,0] op_sel_hi:[1,0] neg_lo:[0,1] neg_hi:[0,1]
    v_pk_add_f32 v[52:53], v[52:53], v[90:91] op_sel:[0,0] op_sel_hi:[1,0] neg_lo:[0,1] neg_hi:[0,1]
    v_pk_add_f32 v[54:55], v[54:55], v[90:91] op_sel:[0,0] op_sel_hi:[1,0] neg_lo:[0,1] neg_hi:[0,1]
    v_pk_mul_f32 v[48:49], v[48:49], v[88:89] op_sel:[0,1] op_sel_hi:[1,1]
    v_pk_mul_f32 v[50:51], v[50:51], v[88:89] op_sel:[0,1] op_sel_hi:[1,1]
    v_pk_mul_f32 v[52:53], v[52:53], v[90:91] op_sel:[0,1] op_sel_hi:[1,1]
    v_pk_mul_f32 v[54:55], v[54:55], v[90:91] op_sel:[0,1] op_sel_hi:[1,1]
    v_cvt_pk_bf16_f32 v144, v48, v49
    v_cvt_pk_bf16_f32 v145, v50, v51
    v_cvt_pk_bf16_f32 v146, v52, v53
    v_cvt_pk_bf16_f32 v147, v54, v55
    ds_write_b64 v6, v[144:145] offset:64
    ds_write_b64 v6, v[146:147] offset:2240
    v_pk_add_f32 v[56:57], v[56:57], v[88:89] op_sel:[0,0] op_sel_hi:[1,0] neg_lo:[0,1] neg_hi:[0,1]
    v_pk_add_f32 v[58:59], v[58:59], v[88:89] op_sel:[0,0] op_sel_hi:[1,0] neg_lo:[0,1] neg_hi:[0,1]
    v_pk_add_f32 v[60:61], v[60:61], v[90:91] op_sel:[0,0] op_sel_hi:[1,0] neg_lo:[0,1] neg_hi:[0,1]
    v_pk_add_f32 v[62:63], v[62:63], v[90:91] op_sel:[0,0] op_sel_hi:[1,0] neg_lo:[0,1] neg_hi:[0,1]
    v_pk_mul_f32 v[56:57], v[56:57], v[88:89] op_sel:[0,1] op_sel_hi:[1,1]
    v_pk_mul_f32 v[58:59], v[58:59], v[88:89] op_sel:[0,1] op_sel_hi:[1,1]
    v_pk_mul_f32 v[60:61], v[60:61], v[90:91] op_sel:[0,1] op_sel_hi:[1,1]
    v_pk_mul_f32 v[62:63], v[62:63], v[90:91] op_sel:[0,1] op_sel_hi:[1,1]
    v_cvt_pk_bf16_f32 v148, v56, v57
    v_cvt_pk_bf16_f32 v149, v58, v59
    v_cvt_pk_bf16_f32 v150, v60, v61
    v_cvt_pk_bf16_f32 v151, v62, v63
    ds_write_b64 v6, v[148:149] offset:96
    ds_write_b64 v6, v[150:151] offset:2272
    s_waitcnt lgkmcnt(0)
    ds_read_b64_tr_b16 v[136:137], v7 offset:0
    ds_read_b64_tr_b16 v[138:139], v7 offset:2176
    ds_read_b64_tr_b16 v[140:141], v7 offset:32
    ds_read_b64_tr_b16 v[142:143], v7 offset:2208
    ds_read_b64_tr_b16 v[144:145], v7 offset:64
    ds_read_b64_tr_b16 v[146:147], v7 offset:2240
    ds_read_b64_tr_b16 v[148:149], v7 offset:96
    ds_read_b64_tr_b16 v[150:151], v7 offset:2272
    s_waitcnt lgkmcnt(6)
    s_add_u32 s49, s59, 0
    buffer_store_dwordx4 v[136:139], v8, s[24:27], s49 offen sc1
    s_waitcnt lgkmcnt(4)
    s_add_u32 s49, s59, 2048
    buffer_store_dwordx4 v[140:143], v8, s[24:27], s49 offen sc1
    s_waitcnt lgkmcnt(2)
    s_add_u32 s49, s59, 4096
    buffer_store_dwordx4 v[144:147], v8, s[24:27], s49 offen sc1
    s_cmp_eq_u32 s56, 1
    s_cbranch_scc1 MC_fin
    s_waitcnt lgkmcnt(0)
    s_add_u32 s49, s59, 6144
    buffer_store_dwordx4 v[148:151], v8, s[24:27], s49 offen sc1
MC_fin:
    v_lshrrev_b32 v5, 1, v3
    v_lshrrev_b32 v6, 1, v4
    v_xor_b32 v5, v5, v6
    v_lshlrev_b32 v5, 4, v5
    v_lshl_add_u32 v5, v3, 7, v5
    v_and_b32 v6, 1, v4
    v_lshl_add_u32 v5, v6, 3, v5
    s_lshl_b32 s16, s12, 12
    v_add_u32 v20, s16, v5
    s_lshl_b32 s53, s35, 3
    s_lshl_b32 s16, s12, 1
    s_add_u32 s53, s53, s16
    v_lshlrev_b32 v7, 1, v3
    s_lshl_b32 s16, s53, 5
    v_add_u32 v7, s16, v7
    v_mov_b32 v32, 0
    v_mov_b32 v33, 0
    v_mov_b32 v34, 0
    v_mov_b32 v35, 0
    v_mov_b32 v36, 0
    v_mov_b32 v37, 0
    v_mov_b32 v38, 0
    v_mov_b32 v39, 0
    v_mov_b32 v40, 0
    v_mov_b32 v41, 0
    v_mov_b32 v42, 0
    v_mov_b32 v43, 0
    v_mov_b32 v44, 0
    v_mov_b32 v45, 0
    v_mov_b32 v46, 0
    v_mov_b32 v47, 0
    v_mov_b32 v48, 0
    v_mov_b32 v49, 0
    v_mov_b32 v50, 0
    v_mov_b32 v51, 0
    v_mov_b32 v52, 0
    v_mov_b32 v53, 0
    v_mov_b32 v54, 0
    v_mov_b32 v55, 0
    v_mov_b32 v56, 0
    v_mov_b32 v57, 0
    v_mov_b32 v58, 0
    v_mov_b32 v59, 0
    v_mov_b32 v60, 0
    v_mov_b32 v61, 0
    v_mov_b32 v62, 0
    v_mov_b32 v63, 0
    v_mov_b32 v64, 0
    v_mov_b32 v65, 0
    v_mov_b32 v66, 0
    v_mov_b32 v67, 0
    v_mov_b32 v68, 0
    v_mov_b32 v69, 0
    v_mov_b32 v70, 0
    v_mov_b32 v71, 0
    v_mov_b32 v72, 0
    v_mov_b32 v73, 0
    v_mov_b32 v74, 0
    v_mov_b32 v75, 0
    v_mov_b32 v76, 0
    v_mov_b32 v77, 0
    v_mov_b32 v78, 0
    v_mov_b32 v79, 0
    v_mov_b32 v80, 0
    v_mov_b32 v81, 0
    v_mov_b32 v82, 0
    v_mov_b32 v83, 0
    v_mov_b32 v84, 0
    v_mov_b32 v85, 0
    v_mov_b32 v86, 0
    v_mov_b32 v87, 0
    s_waitcnt vmcnt(0) lgkmcnt(0)
    s_barrier
    global_load_ushort v28, v7, s[98:99]
    global_load_ushort v30, v7, s[98:99] offset:32
    s_add_u32 s28, s6, 2621440
    s_addc_u32 s29, s7, 0
    s_mov_b32 s30, 2621440
    s_mov_b32 s31, 0x00020000
    s_mul_i32 s13, s36, 5
    s_add_u32 s13, s13, 0
    s_lshl_b32 s13, s13, 16
    s_lshl_b32 s14, s38, 2
    s_add_u32 s14, s14, s12
    s_lshl_b32 s14, s14, 5
    s_add_u32 s13, s13, s14
    v_lshlrev_b32 v11, 12, v3
    v_lshl_add_u32 v11, v4, 3, v11
    buffer_load_dwordx2 v[16:17], v11, s[28:31], s13 offen
    s_add_u32 s13, s13, 65536
    buffer_load_dwordx2 v[18:19], v11, s[28:31], s13 offen
    s_add_u32 s13, s13, 65536
    buffer_load_dwordx2 v[26:27], v11, s[28:31], s13 offen
    s_add_u32 s13, s13, 65536
    s_mov_b32 s41, 59392
    s_mov_b32 s43, 2048
    s_mov_b32 s42, 0
    s_barrier
    v_add_u32 v21, s41, v20
    v_xor_b32 v22, 32, v21
    v_xor_b32 v23, 64, v21
    v_xor_b32 v24, 96, v21
    v_add_u32 v25, s43, v8
    s_barrier
    ds_read_b64 v[112:113], v21 offset:0
    ds_read_b64 v[114:115], v22 offset:0
    ds_read_b64 v[116:117], v21 offset:2048
    ds_read_b64 v[118:119], v22 offset:2048
    ds_read_b128 v[128:131], v25 offset:0
    ds_read_b128 v[132:135], v25 offset:2048
    ds_read_b128 v[136:139], v25 offset:4096
    ds_read_b128 v[140:143], v25 offset:6144
    ds_read_b128 v[144:147], v25 offset:8192
    ds_read_b128 v[148:151], v25 offset:10240
    ds_read_b128 v[152:155], v25 offset:12288
    ds_read_b64 v[120:121], v23 offset:0
    ds_read_b64 v[122:123], v24 offset:0
    ds_read_b64 v[124:125], v23 offset:2048
    ds_read_b64 v[126:127], v24 offset:2048
    ds_read_b128 v[156:159], v25 offset:1024
    ds_read_b128 v[160:163], v25 offset:3072
    ds_read_b128 v[164:167], v25 offset:5120
    ds_read_b128 v[168:171], v25 offset:7168
    ds_read_b128 v[172:175], v25 offset:9216
    ds_read_b128 v[176:179], v25 offset:11264
    ds_read_b128 v[180:183], v25 offset:13312
    s_add_u32 s41, s41, 16384
    s_cmp_eq_u32 s41, 157696
    s_cselect_b32 s41, 59392, s41
    s_add_u32 s43, s43, 14336
    s_cmp_eq_u32 s43, 59392
    s_cselect_b32 s43, 2048, s43
    v_add_u32 v21, s41, v20
    v_xor_b32 v22, 32, v21
    v_xor_b32 v23, 64, v21
    v_xor_b32 v24, 96, v21
    v_add_u32 v25, s43, v8
MD_loop:
    s_waitcnt lgkmcnt(0)
    s_barrier
    v_mfma_f32_16x16x32_bf16 v[32:35], v[128:131], v[112:115], v[32:35]
    ds_read_b64 v[184:185], v21 offset:0
    ds_read_b64 v[186:187], v22 offset:0
    v_mfma_f32_16x16x32_bf16 v[36:39], v[128:131], v[116:119], v[36:39]
    ds_read_b64 v[188:189], v21 offset:2048
    ds_read_b64 v[190:191], v22 offset:2048
    v_mfma_f32_16x16x32_bf16 v[40:43], v[132:135], v[112:115], v[40:43]
    ds_read_b128 v[200:203], v25 offset:0
    v_mfma_f32_16x16x32_bf16 v[44:47], v[132:135], v[116:119], v[44:47]
    ds_read_b128 v[204:207], v25 offset:2048
    ds_read_b128 v[208:211], v25 offset:4096
    v_mfma_f32_16x16x32_bf16 v[48:51], v[136:139], v[112:115], v[48:51]
    ds_read_b128 v[212:215], v25 offset:6144
    v_mfma_f32_16x16x32_bf16 v[52:55], v[136:139], v[116:119], v[52:55]
    ds_read_b128 v[216:219], v25 offset:8192
    ds_read_b128 v[220:223], v25 offset:10240
    v_mfma_f32_16x16x32_bf16 v[56:59], v[140:143], v[112:115], v[56:59]
    ds_read_b128 v[224:227], v25 offset:12288
    v_mfma_f32_16x16x32_bf16 v[60:63], v[140:143], v[116:119], v[60:63]
    ds_read_b64 v[192:193], v23 offset:0
    ds_read_b64 v[194:195], v24 offset:0
    v_mfma_f32_16x16x32_bf16 v[64:67], v[144:147], v[112:115], v[64:67]
    ds_read_b64 v[196:197], v23 offset:2048
    ds_read_b64 v[198:199], v24 offset:2048
    v_mfma_f32_16x16x32_bf16 v[68:71], v[144:147], v[116:119], v[68:71]
    ds_read_b128 v[228:231], v25 offset:1024
    v_mfma_f32_16x16x32_bf16 v[72:75], v[148:151], v[112:115], v[72:75]
    ds_read_b128 v[232:235], v25 offset:3072
    ds_read_b128 v[236:239], v25 offset:5120
    v_mfma_f32_16x16x32_bf16 v[76:79], v[148:151], v[116:119], v[76:79]
    ds_read_b128 v[240:243], v25 offset:7168
    v_mfma_f32_16x16x32_bf16 v[80:83], v[152:155], v[112:115], v[80:83]
    ds_read_b128 v[244:247], v25 offset:9216
    ds_read_b128 v[248:251], v25 offset:11264
    v_mfma_f32_16x16x32_bf16 v[84:87], v[152:155], v[116:119], v[84:87]
    ds_read_b128 v[252:255], v25 offset:13312
    v_mfma_f32_16x16x32_bf16 v[32:35], v[156:159], v[120:123], v[32:35]
    s_add_u32 s41, s41, 16384
    v_mfma_f32_16x16x32_bf16 v[36:39], v[156:159], v[124:127], v[36:39]
    s_cmp_eq_u32 s41, 157696
    v_mfma_f32_16x16x32_bf16 v[40:43], v[160:163], v[120:123], v[40:43]
    s_cselect_b32 s41, 59392, s41
    v_mfma_f32_16x16x32_bf16 v[44:47], v[160:163], v[124:127], v[44:47]
    s_add_u32 s43, s43, 14336
    v_mfma_f32_16x16x32_bf16 v[48:51], v[164:167], v[120:123], v[48:51]
    s_cmp_eq_u32 s43, 59392
    v_mfma_f32_16x16x32_bf16 v[52:55], v[164:167], v[124:127], v[52:55]
    s_cselect_b32 s43, 2048, s43
    v_mfma_f32_16x16x32_bf16 v[56:59], v[168:171], v[120:123], v[56:59]
    v_mfma_f32_16x16x32_bf16 v[60:63], v[168:171], v[124:127], v[60:63]
    v_add_u32 v21, s41, v20
    v_mfma_f32_16x16x32_bf16 v[64:67], v[172:175], v[120:123], v[64:67]
    v_xor_b32 v22, 32, v21
    v_mfma_f32_16x16x32_bf16 v[68:71], v[172:175], v[124:127], v[68:71]
    v_xor_b32 v23, 64, v21
    v_mfma_f32_16x16x32_bf16 v[72:75], v[176:179], v[120:123], v[72:75]
    v_xor_b32 v24, 96, v21
    v_mfma_f32_16x16x32_bf16 v[76:79], v[176:179], v[124:127], v[76:79]
    v_add_u32 v25, s43, v8
    v_mfma_f32_16x16x32_bf16 v[80:83], v[180:183], v[120:123], v[80:83]
    s_add_u32 s42, s42, 1
    v_mfma_f32_16x16x32_bf16 v[84:87], v[180:183], v[124:127], v[84:87]
    s_waitcnt lgkmcnt(0)
    s_barrier
    v_mfma_f32_16x16x32_bf16 v[32:35], v[200:203], v[184:187], v[32:35]
    ds_read_b64 v[112:113], v21 offset:0
    ds_read_b64 v[114:115], v22 offset:0
    v_mfma_f32_16x16x32_bf16 v[36:39], v[200:203], v[188:191], v[36:39]
    ds_read_b64 v[116:117], v21 offset:2048
    ds_read_b64 v[118:119], v22 offset:2048
    v_mfma_f32_16x16x32_bf16 v[40:43], v[204:207], v[184:187], v[40:43]
    ds_read_b128 v[128:131], v25 offset:0
    v_mfma_f32_16x16x32_bf16 v[44:47], v[204:207], v[188:191], v[44:47]
    ds_read_b128 v[132:135], v25 offset:2048
    ds_read_b128 v[136:139], v25 offset:4096
    v_mfma_f32_16x16x32_bf16 v[48:51], v[208:211], v[184:187], v[48:51]
    ds_read_b128 v[140:143], v25 offset:6144
    v_mfma_f32_16x16x32_bf16 v[52:55], v[208:211], v[188:191], v[52:55]
    ds_read_b128 v[144:147], v25 offset:8192
    ds_read_b128 v[148:151], v25 offset:10240
    v_mfma_f32_16x16x32_bf16 v[56:59], v[212:215], v[184:187], v[56:59]
    ds_read_b128 v[152:155], v25 offset:12288
    v_mfma_f32_16x16x32_bf16 v[60:63], v[212:215], v[188:191], v[60:63]
    ds_read_b64 v[120:121], v23 offset:0
    ds_read_b64 v[122:123], v24 offset:0
    v_mfma_f32_16x16x32_bf16 v[64:67], v[216:219], v[184:187], v[64:67]
    ds_read_b64 v[124:125], v23 offset:2048
    ds_read_b64 v[126:127], v24 offset:2048
    v_mfma_f32_16x16x32_bf16 v[68:71], v[216:219], v[188:191], v[68:71]
    ds_read_b128 v[156:159], v25 offset:1024
    v_mfma_f32_16x16x32_bf16 v[72:75], v[220:223], v[184:187], v[72:75]
    ds_read_b128 v[160:163], v25 offset:3072
    ds_read_b128 v[164:167], v25 offset:5120
    v_mfma_f32_16x16x32_bf16 v[76:79], v[220:223], v[188:191], v[76:79]
    ds_read_b128 v[168:171], v25 offset:7168
    v_mfma_f32_16x16x32_bf16 v[80:83], v[224:227], v[184:187], v[80:83]
    ds_read_b128 v[172:175], v25 offset:9216
    ds_read_b128 v[176:179], v25 offset:11264
    v_mfma_f32_16x16x32_bf16 v[84:87], v[224:227], v[188:191], v[84:87]
    ds_read_b128 v[180:183], v25 offset:13312
    v_mfma_f32_16x16x32_bf16 v[32:35], v[228:231], v[192:195], v[32:35]
    s_add_u32 s41, s41, 16384
    v_mfma_f32_16x16x32_bf16 v[36:39], v[228:231], v[196:199], v[36:39]
    s_cmp_eq_u32 s41, 157696
    v_mfma_f32_16x16x32_bf16 v[40:43], v[232:235], v[192:195], v[40:43]
    s_cselect_b32 s41, 59392, s41
    v_mfma_f32_16x16x32_bf16 v[44:47], v[232:235], v[196:199], v[44:47]
    s_add_u32 s43, s43, 14336
    v_mfma_f32_16x16x32_bf16 v[48:51], v[236:239], v[192:195], v[48:51]
    s_cmp_eq_u32 s43, 59392
    v_mfma_f32_16x16x32_bf16 v[52:55], v[236:239], v[196:199], v[52:55]
    s_cselect_b32 s43, 2048, s43
    v_mfma_f32_16x16x32_bf16 v[56:59], v[240:243], v[192:195], v[56:59]
    v_mfma_f32_16x16x32_bf16 v[60:63], v[240:243], v[196:199], v[60:63]
    v_add_u32 v21, s41, v20
    v_mfma_f32_16x16x32_bf16 v[64:67], v[244:247], v[192:195], v[64:67]
    v_xor_b32 v22, 32, v21
    v_mfma_f32_16x16x32_bf16 v[68:71], v[244:247], v[196:199], v[68:71]
    v_xor_b32 v23, 64, v21
    v_mfma_f32_16x16x32_bf16 v[72:75], v[248:251], v[192:195], v[72:75]
    v_xor_b32 v24, 96, v21
    v_mfma_f32_16x16x32_bf16 v[76:79], v[248:251], v[196:199], v[76:79]
    v_add_u32 v25, s43, v8
    v_mfma_f32_16x16x32_bf16 v[80:83], v[252:255], v[192:195], v[80:83]
    s_add_u32 s42, s42, 1
    v_mfma_f32_16x16x32_bf16 v[84:87], v[252:255], v[196:199], v[84:87]
    s_cmp_lt_u32 s42, 16
    s_cbranch_scc1 MD_loop
    s_lshr_b32 s16, s2, 1
    s_lshl_b32 s16, s16, 2
    s_add_u32 s16, s16, s12
    s_mul_i32 s48, s16, 7168
    s_add_u32 s55, s48, 4096
    s_lshl_b32 s16, s2, 2
    s_add_u32 s16, s16, s12
    s_lshl_b32 s16, s16, 7
    s_add_u32 s17, s16, 43548672
    v_mov_b32 v10, s17
    s_xor_b32 s16, s16, 512
    s_add_u32 s17, s16, 43548672
    v_mov_b32 v11, s17
    v_mov_b32 v6, 1
    s_add_u32 s20, s6, 11599872
    s_addc_u32 s21, s7, 0
    s_mov_b32 s22, 3670016
    s_mov_b32 s23, 0x00020000
    s_waitcnt vmcnt(0) lgkmcnt(0)
    s_cmp_eq_u32 s37, 0
    s_cbranch_scc1 MD_e0
    v_cvt_pk_bf16_f32 v112, v64, v65
    v_cvt_pk_bf16_f32 v113, v66, v67
    v_cvt_pk_bf16_f32 v114, v68, v69
    v_cvt_pk_bf16_f32 v115, v70, v71
    buffer_store_dwordx4 v[112:115], v8, s[20:23], s55 offen offset:0 sc1
    v_cvt_pk_bf16_f32 v116, v72, v73
    v_cvt_pk_bf16_f32 v117, v74, v75
    v_cvt_pk_bf16_f32 v118, v76, v77
    v_cvt_pk_bf16_f32 v119, v78, v79
    buffer_store_dwordx4 v[116:119], v8, s[20:23], s55 offen offset:1024 sc1
    v_cvt_pk_bf16_f32 v120, v80, v81
    v_cvt_pk_bf16_f32 v121, v82, v83
    v_cvt_pk_bf16_f32 v122, v84, v85
    v_cvt_pk_bf16_f32 v123, v86, v87
    buffer_store_dwordx4 v[120:123], v8, s[20:23], s55 offen offset:2048 sc1
    s_lshr_b32 s16, s53, 2
    s_mul_i32 s17, s16, 114688
    s_add_u32 s24, s6, s17
    s_addc_u32 s25, s7, 0
    s_add_u32 s24, s24, 36044800
    s_addc_u32 s25, s25, 0
    s_mov_b32 s26, 114688
    s_mov_b32 s27, 0x00020000
    s_lshr_b32 s49, s36, 1
    s_mul_i32 s49, s49, 7
    s_and_b32 s51, s36, 1
    s_and_b32 s50, s53, 3
    s_lshl_b32 s50, s50, 10
    s_add_u32 s52, s49, 6
    s_lshl_b32 s52, s52, 12
    s_add_u32 s52, s52, s50
    s_lshl_b32 s54, s51, 9
    s_add_u32 s52, s52, s54
    s_mul_i32 s54, s51, 3
    s_add_u32 s49, s49, s54
    s_lshl_b32 s49, s49, 12
    s_add_u32 s49, s49, s50
    s_lshl_b32 s16, s16, 12
    s_lshl_b32 s17, s36, 1
    s_add_u32 s17, s17, s37
    s_lshl_b32 s17, s17, 1
    s_and_b32 s54, s12, 1
    s_add_u32 s17, s17, s54
    s_lshl_b32 s17, s17, 7
    s_add_u32 s16, s16, s17
    s_add_u32 s16, s16, 43417600
    v_mov_b32 v5, s16
    s_lshl_b32 s16, s38, 12
    s_add_u32 s16, s16, 43417600
    v_and_b32 v7, 31, v1
    v_lshl_add_u32 v7, v7, 7, s16
    v_lshlrev_b32 v28, 16, v28
    v_lshlrev_b32 v30, 16, v30
    v_lshlrev_b32 v144, 16, v92
    v_and_b32 v145, 0xffff0000, v92
    v_lshlrev_b32 v146, 16, v93
    v_and_b32 v147, 0xffff0000, v93
    v_lshlrev_b32 v148, 16, v94
    v_and_b32 v149, 0xffff0000, v94
    v_lshlrev_b32 v150, 16, v95
    v_and_b32 v151, 0xffff0000, v95
    v_lshlrev_b32 v152, 16, v96
    v_and_b32 v153, 0xffff0000, v96
    v_lshlrev_b32 v154, 16, v97
    v_and_b32 v155, 0xffff0000, v97
    v_lshlrev_b32 v156, 16, v98
    v_and_b32 v157, 0xffff0000, v98
    v_lshlrev_b32 v158, 16, v99
    v_and_b32 v159, 0xffff0000, v99
    v_lshlrev_b32 v160, 16, v100
    v_and_b32 v161, 0xffff0000, v100
    v_lshlrev_b32 v162, 16, v101
    v_and_b32 v163, 0xffff0000, v101
    v_lshlrev_b32 v164, 16, v102
    v_and_b32 v165, 0xffff0000, v102
    v_lshlrev_b32 v166, 16, v103
    v_and_b32 v167, 0xffff0000, v103
    v_lshlrev_b32 v168, 16, v104
    v_and_b32 v169, 0xffff0000, v104
    v_lshlrev_b32 v170, 16, v105
    v_and_b32 v171, 0xffff0000, v105
    v_lshlrev_b32 v172, 16, v106
    v_and_b32 v173, 0xffff0000, v106
    v_lshlrev_b32 v174, 16, v107
    v_and_b32 v175, 0xffff0000, v107
    s_waitcnt vmcnt(0)
    s_mov_b64 exec, 1
    global_store_dword v10, v6, s[6:7] sc1
    s_mov_b64 exec, -1
MD1_fp:
    global_load_dword v12, v11, s[6:7] sc1
    s_waitcnt vmcnt(0)
    v_cmp_ne_u32 vcc, 1, v12
    s_nop 3
    s_cbranch_vccz MD1_go
    s_sleep 3
    s_branch MD1_fp
MD1_go:
    buffer_load_dwordx4 v[128:131], v8, s[20:23], s48 offen offset:0 sc1
    buffer_load_dwordx4 v[132:135], v8, s[20:23], s48 offen offset:1024 sc1
    buffer_load_dwordx4 v[136:139], v8, s[20:23], s48 offen offset:2048 sc1
    buffer_load_dwordx4 v[140:143], v8, s[20:23], s48 offen offset:3072 sc1
    s_waitcnt vmcnt(3)
    v_lshlrev_b32 v176, 16, v128
    v_and_b32 v177, 0xffff0000, v128
    v_lshlrev_b32 v178, 16, v129
    v_and_b32 v179, 0xffff0000, v129
    v_lshlrev_b32 v180, 16, v130
    v_and_b32 v181, 0xffff0000, v130
    v_lshlrev_b32 v182, 16, v131
    v_and_b32 v183, 0xffff0000, v131
    v_pk_add_f32 v[32:33], v[32:33], v[176:177]
    v_pk_add_f32 v[34:35], v[34:35], v[178:179]
    v_pk_add_f32 v[36:37], v[36:37], v[180:181]
    v_pk_add_f32 v[38:39], v[38:39], v[182:183]
    v_cvt_pk_bf16_f32 v176, v32, v33
    v_cvt_pk_bf16_f32 v178, v34, v35
    v_cvt_pk_bf16_f32 v180, v36, v37
    v_cvt_pk_bf16_f32 v182, v38, v39
    v_lshlrev_b32 v32, 16, v176
    v_and_b32 v33, 0xffff0000, v176
    v_lshlrev_b32 v34, 16, v178
    v_and_b32 v35, 0xffff0000, v178
    v_lshlrev_b32 v36, 16, v180
    v_and_b32 v37, 0xffff0000, v180
    v_lshlrev_b32 v38, 16, v182
    v_and_b32 v39, 0xffff0000, v182
    v_pk_add_f32 v[32:33], v[32:33], v[28:29] op_sel:[0,0] op_sel_hi:[1,0]
    v_pk_add_f32 v[34:35], v[34:35], v[28:29] op_sel:[0,0] op_sel_hi:[1,0]
    v_pk_add_f32 v[36:37], v[36:37], v[30:31] op_sel:[0,0] op_sel_hi:[1,0]
    v_pk_add_f32 v[38:39], v[38:39], v[30:31] op_sel:[0,0] op_sel_hi:[1,0]
    v_cvt_pk_bf16_f32 v176, v32, v33
    v_cvt_pk_bf16_f32 v178, v34, v35
    v_cvt_pk_bf16_f32 v180, v36, v37
    v_cvt_pk_bf16_f32 v182, v38, v39
    v_lshlrev_b32 v32, 16, v176
    v_and_b32 v33, 0xffff0000, v176
    v_lshlrev_b32 v34, 16, v178
    v_and_b32 v35, 0xffff0000, v178
    v_lshlrev_b32 v36, 16, v180
    v_and_b32 v37, 0xffff0000, v180
    v_lshlrev_b32 v38, 16, v182
    v_and_b32 v39, 0xffff0000, v182
    v_pk_mul_f32 v[32:33], v[32:33], v[144:145]
    v_pk_mul_f32 v[34:35], v[34:35], v[146:147]
    v_pk_mul_f32 v[36:37], v[36:37], v[148:149]
    v_pk_mul_f32 v[38:39], v[38:39], v[150:151]
    v_cvt_pk_bf16_f32 v200, v32, v33
    v_cvt_pk_bf16_f32 v201, v34, v35
    v_cvt_pk_bf16_f32 v204, v36, v37
    v_cvt_pk_bf16_f32 v205, v38, v39
    s_waitcnt vmcnt(2)
    v_lshlrev_b32 v176, 16, v132
    v_and_b32 v177, 0xffff0000, v132
    v_lshlrev_b32 v178, 16, v133
    v_and_b32 v179, 0xffff0000, v133
    v_lshlrev_b32 v180, 16, v134
    v_and_b32 v181, 0xffff0000, v134
    v_lshlrev_b32 v182, 16, v135
    v_and_b32 v183, 0xffff0000, v135
    v_pk_add_f32 v[40:41], v[40:41], v[176:177]
    v_pk_add_f32 v[42:43], v[42:43], v[178:179]
    v_pk_add_f32 v[44:45], v[44:45], v[180:181]
    v_pk_add_f32 v[46:47], v[46:47], v[182:183]
    v_cvt_pk_bf16_f32 v176, v40, v41
    v_cvt_pk_bf16_f32 v178, v42, v43
    v_cvt_pk_bf16_f32 v180, v44, v45
    v_cvt_pk_bf16_f32 v182, v46, v47
    v_lshlrev_b32 v40, 16, v176
    v_and_b32 v41, 0xffff0000, v176
    v_lshlrev_b32 v42, 16, v178
    v_and_b32 v43, 0xffff0000, v178
    v_lshlrev_b32 v44, 16, v180
    v_and_b32 v45, 0xffff0000, v180
    v_lshlrev_b32 v46, 16, v182
    v_and_b32 v47, 0xffff0000, v182
    v_pk_add_f32 v[40:41], v[40:41], v[28:29] op_sel:[0,0] op_sel_hi:[1,0]
    v_pk_add_f32 v[42:43], v[42:43], v[28:29] op_sel:[0,0] op_sel_hi:[1,0]
    v_pk_add_f32 v[44:45], v[44:45], v[30:31] op_sel:[0,0] op_sel_hi:[1,0]
    v_pk_add_f32 v[46:47], v[46:47], v[30:31] op_sel:[0,0] op_sel_hi:[1,0]
    v_cvt_pk_bf16_f32 v176, v40, v41
    v_cvt_pk_bf16_f32 v178, v42, v43
    v_cvt_pk_bf16_f32 v180, v44, v45
    v_cvt_pk_bf16_f32 v182, v46, v47
    v_lshlrev_b32 v40, 16, v176
    v_and_b32 v41, 0xffff0000, v176
    v_lshlrev_b32 v42, 16, v178
    v_and_b32 v43, 0xffff0000, v178
    v_lshlrev_b32 v44, 16, v180
    v_and_b32 v45, 0xffff0000, v180
    v_lshlrev_b32 v46, 16, v182
    v_and_b32 v47, 0xffff0000, v182
    v_pk_mul_f32 v[40:41], v[40:41], v[152:153]
    v_pk_mul_f32 v[42:43], v[42:43], v[154:155]
    v_pk_mul_f32 v[44:45], v[44:45], v[156:157]
    v_pk_mul_f32 v[46:47], v[46:47], v[158:159]
    v_cvt_pk_bf16_f32 v202, v40, v41
    v_cvt_pk_bf16_f32 v203, v42, v43
    v_cvt_pk_bf16_f32 v206, v44, v45
    v_cvt_pk_bf16_f32 v207, v46, v47
    s_add_u32 s54, s49, 0
    buffer_store_dwordx4 v[200:203], v8, s[24:27], s54 offen offset:0 sc1
    buffer_store_dwordx4 v[204:207], v8, s[24:27], s54 offen offset:1024 sc1
    s_waitcnt vmcnt(3)
    v_lshlrev_b32 v176, 16, v136
    v_and_b32 v177, 0xffff0000, v136
    v_lshlrev_b32 v178, 16, v137
    v_and_b32 v179, 0xffff0000, v137
    v_lshlrev_b32 v180, 16, v138
    v_and_b32 v181, 0xffff0000, v138
    v_lshlrev_b32 v182, 16, v139
    v_and_b32 v183, 0xffff0000, v139
    v_pk_add_f32 v[48:49], v[48:49], v[176:177]
    v_pk_add_f32 v[50:51], v[50:51], v[178:179]
    v_pk_add_f32 v[52:53], v[52:53], v[180:181]
    v_pk_add_f32 v[54:55], v[54:55], v[182:183]
    v_cvt_pk_bf16_f32 v176, v48, v49
    v_cvt_pk_bf16_f32 v178, v50, v51
    v_cvt_pk_bf16_f32 v180, v52, v53
    v_cvt_pk_bf16_f32 v182, v54, v55
    v_lshlrev_b32 v48, 16, v176
    v_and_b32 v49, 0xffff0000, v176
    v_lshlrev_b32 v50, 16, v178
    v_and_b32 v51, 0xffff0000, v178
    v_lshlrev_b32 v52, 16, v180
    v_and_b32 v53, 0xffff0000, v180
    v_lshlrev_b32 v54, 16, v182
    v_and_b32 v55, 0xffff0000, v182
    v_pk_add_f32 v[48:49], v[48:49], v[28:29] op_sel:[0,0] op_sel_hi:[1,0]
    v_pk_add_f32 v[50:51], v[50:51], v[28:29] op_sel:[0,0] op_sel_hi:[1,0]
    v_pk_add_f32 v[52:53], v[52:53], v[30:31] op_sel:[0,0] op_sel_hi:[1,0]
    v_pk_add_f32 v[54:55], v[54:55], v[30:31] op_sel:[0,0] op_sel_hi:[1,0]
    v_cvt_pk_bf16_f32 v176, v48, v49
    v_cvt_pk_bf16_f32 v178, v50, v51
    v_cvt_pk_bf16_f32 v180, v52, v53
    v_cvt_pk_bf16_f32 v182, v54, v55
    v_lshlrev_b32 v48, 16, v176
    v_and_b32 v49, 0xffff0000, v176
    v_lshlrev_b32 v50, 16, v178
    v_and_b32 v51, 0xffff0000, v178
    v_lshlrev_b32 v52, 16, v180
    v_and_b32 v53, 0xffff0000, v180
    v_lshlrev_b32 v54, 16, v182
    v_and_b32 v55, 0xffff0000, v182
    v_pk_mul_f32 v[48:49], v[48:49], v[160:161]
    v_pk_mul_f32 v[50:51], v[50:51], v[162:163]
    v_pk_mul_f32 v[52:53], v[52:53], v[164:165]
    v_pk_mul_f32 v[54:55], v[54:55], v[166:167]
    v_cvt_pk_bf16_f32 v208, v48, v49
    v_cvt_pk_bf16_f32 v209, v50, v51
    v_cvt_pk_bf16_f32 v212, v52, v53
    v_cvt_pk_bf16_f32 v213, v54, v55
    s_waitcnt vmcnt(2)
    v_lshlrev_b32 v176, 16, v140
    v_and_b32 v177, 0xffff0000, v140
    v_lshlrev_b32 v178, 16, v141
    v_and_b32 v179, 0xffff0000, v141
    v_lshlrev_b32 v180, 16, v142
    v_and_b32 v181, 0xffff0000, v142
    v_lshlrev_b32 v182, 16, v143
    v_and_b32 v183, 0xffff0000, v143
    v_pk_add_f32 v[56:57], v[56:57], v[176:177]
    v_pk_add_f32 v[58:59], v[58:59], v[178:179]
    v_pk_add_f32 v[60:61], v[60:61], v[180:181]
    v_pk_add_f32 v[62:63], v[62:63], v[182:183]
    v_cvt_pk_bf16_f32 v176, v56, v57
    v_cvt_pk_bf16_f32 v178, v58, v59
    v_cvt_pk_bf16_f32 v180, v60, v61
    v_cvt_pk_bf16_f32 v182, v62, v63
    v_lshlrev_b32 v56, 16, v176
    v_and_b32 v57, 0xffff0000, v176
    v_lshlrev_b32 v58, 16, v178
    v_and_b32 v59, 0xffff0000, v178
    v_lshlrev_b32 v60, 16, v180
    v_and_b32 v61, 0xffff0000, v180
    v_lshlrev_b32 v62, 16, v182
    v_and_b32 v63, 0xffff0000, v182
    v_pk_add_f32 v[56:57], v[56:57], v[28:29] op_sel:[0,0] op_sel_hi:[1,0]
    v_pk_add_f32 v[58:59], v[58:59], v[28:29] op_sel:[0,0] op_sel_hi:[1,0]
    v_pk_add_f32 v[60:61], v[60:61], v[30:31] op_sel:[0,0] op_sel_hi:[1,0]
    v_pk_add_f32 v[62:63], v[62:63], v[30:31] op_sel:[0,0] op_sel_hi:[1,0]
    v_cvt_pk_bf16_f32 v176, v56, v57
    v_cvt_pk_bf16_f32 v178, v58, v59
    v_cvt_pk_bf16_f32 v180, v60, v61
    v_cvt_pk_bf16_f32 v182, v62, v63
    v_lshlrev_b32 v56, 16, v176
    v_and_b32 v57, 0xffff0000, v176
    v_lshlrev_b32 v58, 16, v178
    v_and_b32 v59, 0xffff0000, v178
    v_lshlrev_b32 v60, 16, v180
    v_and_b32 v61, 0xffff0000, v180
    v_lshlrev_b32 v62, 16, v182
    v_and_b32 v63, 0xffff0000, v182
    v_pk_mul_f32 v[56:57], v[56:57], v[168:169]
    v_pk_mul_f32 v[58:59], v[58:59], v[170:171]
    v_pk_mul_f32 v[60:61], v[60:61], v[172:173]
    v_pk_mul_f32 v[62:63], v[62:63], v[174:175]
    v_cvt_pk_bf16_f32 v210, v56, v57
    v_cvt_pk_bf16_f32 v211, v58, v59
    v_cvt_pk_bf16_f32 v214, v60, v61
    v_cvt_pk_bf16_f32 v215, v62, v63
    s_add_u32 s54, s49, 4096
    buffer_store_dwordx4 v[208:211], v8, s[24:27], s54 offen offset:0 sc1
    buffer_store_dwordx4 v[212:215], v8, s[24:27], s54 offen offset:1024 sc1
    s_branch MD_ed
MD_e0:
    v_cvt_pk_bf16_f32 v112, v32, v33
    v_cvt_pk_bf16_f32 v113, v34, v35
    v_cvt_pk_bf16_f32 v114, v36, v37
    v_cvt_pk_bf16_f32 v115, v38, v39
    buffer_store_dwordx4 v[112:115], v8, s[20:23], s48 offen offset:0 sc1
    v_cvt_pk_bf16_f32 v116, v40, v41
    v_cvt_pk_bf16_f32 v117, v42, v43
    v_cvt_pk_bf16_f32 v118, v44, v45
    v_cvt_pk_bf16_f32 v119, v46, v47
    buffer_store_dwordx4 v[116:119], v8, s[20:23], s48 offen offset:1024 sc1
    v_cvt_pk_bf16_f32 v120, v48, v49
    v_cvt_pk_bf16_f32 v121, v50, v51
    v_cvt_pk_bf16_f32 v122, v52, v53
    v_cvt_pk_bf16_f32 v123, v54, v55
    buffer_store_dwordx4 v[120:123], v8, s[20:23], s48 offen offset:2048 sc1
    v_cvt_pk_bf16_f32 v124, v56, v57
    v_cvt_pk_bf16_f32 v125, v58, v59
    v_cvt_pk_bf16_f32 v126, v60, v61
    v_cvt_pk_bf16_f32 v127, v62, v63
    buffer_store_dwordx4 v[124:127], v8, s[20:23], s48 offen offset:3072 sc1
    s_lshr_b32 s16, s53, 2
    s_mul_i32 s17, s16, 114688
    s_add_u32 s24, s6, s17
    s_addc_u32 s25, s7, 0
    s_add_u32 s24, s24, 36044800
    s_addc_u32 s25, s25, 0
    s_mov_b32 s26, 114688
    s_mov_b32 s27, 0x00020000
    s_lshr_b32 s49, s36, 1
    s_mul_i32 s49, s49, 7
    s_and_b32 s51, s36, 1
    s_and_b32 s50, s53, 3
    s_lshl_b32 s50, s50, 10
    s_add_u32 s52, s49, 6
    s_lshl_b32 s52, s52, 12
    s_add_u32 s52, s52, s50
    s_lshl_b32 s54, s51, 9
    s_add_u32 s52, s52, s54
    s_mul_i32 s54, s51, 3
    s_add_u32 s49, s49, s54
    s_lshl_b32 s49, s49, 12
    s_add_u32 s49, s49, s50
    s_lshl_b32 s16, s16, 12
    s_lshl_b32 s17, s36, 1
    s_add_u32 s17, s17, s37
    s_lshl_b32 s17, s17, 1
    s_and_b32 s54, s12, 1
    s_add_u32 s17, s17, s54
    s_lshl_b32 s17, s17, 7
    s_add_u32 s16, s16, s17
    s_add_u32 s16, s16, 43417600
    v_mov_b32 v5, s16
    s_lshl_b32 s16, s38, 12
    s_add_u32 s16, s16, 43417600
    v_and_b32 v7, 31, v1
    v_lshl_add_u32 v7, v7, 7, s16
    v_lshlrev_b32 v28, 16, v28
    v_lshlrev_b32 v30, 16, v30
    v_lshlrev_b32 v144, 16, v96
    v_and_b32 v145, 0xffff0000, v96
    v_lshlrev_b32 v146, 16, v97
    v_and_b32 v147, 0xffff0000, v97
    v_lshlrev_b32 v148, 16, v98
    v_and_b32 v149, 0xffff0000, v98
    v_lshlrev_b32 v150, 16, v99
    v_and_b32 v151, 0xffff0000, v99
    v_lshlrev_b32 v152, 16, v100
    v_and_b32 v153, 0xffff0000, v100
    v_lshlrev_b32 v154, 16, v101
    v_and_b32 v155, 0xffff0000, v101
    v_lshlrev_b32 v156, 16, v102
    v_and_b32 v157, 0xffff0000, v102
    v_lshlrev_b32 v158, 16, v103
    v_and_b32 v159, 0xffff0000, v103
    v_lshlrev_b32 v160, 16, v104
    v_and_b32 v161, 0xffff0000, v104
    v_lshlrev_b32 v162, 16, v105
    v_and_b32 v163, 0xffff0000, v105
    v_lshlrev_b32 v164, 16, v106
    v_and_b32 v165, 0xffff0000, v106
    v_lshlrev_b32 v166, 16, v107
    v_and_b32 v167, 0xffff0000, v107
    s_waitcnt vmcnt(0)
    s_mov_b64 exec, 1
    global_store_dword v10, v6, s[6:7] sc1
    s_mov_b64 exec, -1
MD0_fp:
    global_load_dword v12, v11, s[6:7] sc1
    s_waitcnt vmcnt(0)
    v_cmp_ne_u32 vcc, 1, v12
    s_nop 3
    s_cbranch_vccz MD0_go
    s_sleep 3
    s_branch MD0_fp
MD0_go:
    buffer_load_dwordx4 v[128:131], v8, s[20:23], s55 offen offset:0 sc1
    buffer_load_dwordx4 v[132:135], v8, s[20:23], s55 offen offset:1024 sc1
    buffer_load_dwordx4 v[136:139], v8, s[20:23], s55 offen offset:2048 sc1
    s_waitcnt vmcnt(2)
    v_lshlrev_b32 v176, 16, v128
    v_and_b32 v177, 0xffff0000, v128
    v_lshlrev_b32 v178, 16, v129
    v_and_b32 v179, 0xffff0000, v129
    v_lshlrev_b32 v180, 16, v130
    v_and_b32 v181, 0xffff0000, v130
    v_lshlrev_b32 v182, 16, v131
    v_and_b32 v183, 0xffff0000, v131
    v_pk_add_f32 v[64:65], v[64:65], v[176:177]
    v_pk_add_f32 v[66:67], v[66:67], v[178:179]
    v_pk_add_f32 v[68:69], v[68:69], v[180:181]
    v_pk_add_f32 v[70:71], v[70:71], v[182:183]
    v_cvt_pk_bf16_f32 v176, v64, v65
    v_cvt_pk_bf16_f32 v178, v66, v67
    v_cvt_pk_bf16_f32 v180, v68, v69
    v_cvt_pk_bf16_f32 v182, v70, v71
    v_lshlrev_b32 v64, 16, v176
    v_and_b32 v65, 0xffff0000, v176
    v_lshlrev_b32 v66, 16, v178
    v_and_b32 v67, 0xffff0000, v178
    v_lshlrev_b32 v68, 16, v180
    v_and_b32 v69, 0xffff0000, v180
    v_lshlrev_b32 v70, 16, v182
    v_and_b32 v71, 0xffff0000, v182
    v_pk_add_f32 v[64:65], v[64:65], v[28:29] op_sel:[0,0] op_sel_hi:[1,0]
    v_pk_add_f32 v[66:67], v[66:67], v[28:29] op_sel:[0,0] op_sel_hi:[1,0]
    v_pk_add_f32 v[68:69], v[68:69], v[30:31] op_sel:[0,0] op_sel_hi:[1,0]
    v_pk_add_f32 v[70:71], v[70:71], v[30:31] op_sel:[0,0] op_sel_hi:[1,0]
    v_cvt_pk_bf16_f32 v176, v64, v65
    v_cvt_pk_bf16_f32 v178, v66, v67
    v_cvt_pk_bf16_f32 v180, v68, v69
    v_cvt_pk_bf16_f32 v182, v70, v71
    v_lshlrev_b32 v64, 16, v176
    v_and_b32 v65, 0xffff0000, v176
    v_lshlrev_b32 v66, 16, v178
    v_and_b32 v67, 0xffff0000, v178
    v_lshlrev_b32 v68, 16, v180
    v_and_b32 v69, 0xffff0000, v180
    v_lshlrev_b32 v70, 16, v182
    v_and_b32 v71, 0xffff0000, v182
    v_pk_mul_f32 v[64:65], v[64:65], v[144:145]
    v_pk_mul_f32 v[66:67], v[66:67], v[146:147]
    v_pk_mul_f32 v[68:69], v[68:69], v[148:149]
    v_pk_mul_f32 v[70:71], v[70:71], v[150:151]
    v_cvt_pk_bf16_f32 v200, v64, v65
    v_cvt_pk_bf16_f32 v201, v66, v67
    v_cvt_pk_bf16_f32 v204, v68, v69
    v_cvt_pk_bf16_f32 v205, v70, v71
    s_waitcnt vmcnt(1)
    v_lshlrev_b32 v176, 16, v132
    v_and_b32 v177, 0xffff0000, v132
    v_lshlrev_b32 v178, 16, v133
    v_and_b32 v179, 0xffff0000, v133
    v_lshlrev_b32 v180, 16, v134
    v_and_b32 v181, 0xffff0000, v134
    v_lshlrev_b32 v182, 16, v135
    v_and_b32 v183, 0xffff0000, v135
    v_pk_add_f32 v[72:73], v[72:73], v[176:177]
    v_pk_add_f32 v[74:75], v[74:75], v[178:179]
    v_pk_add_f32 v[76:77], v[76:77], v[180:181]
    v_pk_add_f32 v[78:79], v[78:79], v[182:183]
    v_cvt_pk_bf16_f32 v176, v72, v73
    v_cvt_pk_bf16_f32 v178, v74, v75
    v_cvt_pk_bf16_f32 v180, v76, v77
    v_cvt_pk_bf16_f32 v182, v78, v79
    v_lshlrev_b32 v72, 16, v176
    v_and_b32 v73, 0xffff0000, v176
    v_lshlrev_b32 v74, 16, v178
    v_and_b32 v75, 0xffff0000, v178
    v_lshlrev_b32 v76, 16, v180
    v_and_b32 v77, 0xffff0000, v180
    v_lshlrev_b32 v78, 16, v182
    v_and_b32 v79, 0xffff0000, v182
    v_pk_add_f32 v[72:73], v[72:73], v[28:29] op_sel:[0,0] op_sel_hi:[1,0]
    v_pk_add_f32 v[74:75], v[74:75], v[28:29] op_sel:[0,0] op_sel_hi:[1,0]
    v_pk_add_f32 v[76:77], v[76:77], v[30:31] op_sel:[0,0] op_sel_hi:[1,0]
    v_pk_add_f32 v[78:79], v[78:79], v[30:31] op_sel:[0,0] op_sel_hi:[1,0]
    v_cvt_pk_bf16_f32 v176, v72, v73
    v_cvt_pk_bf16_f32 v178, v74, v75
    v_cvt_pk_bf16_f32 v180, v76, v77
    v_cvt_pk_bf16_f32 v182, v78, v79
    v_lshlrev_b32 v72, 16, v176
    v_and_b32 v73, 0xffff0000, v176
    v_lshlrev_b32 v74, 16, v178
    v_and_b32 v75, 0xffff0000, v178
    v_lshlrev_b32 v76, 16, v180
    v_and_b32 v77, 0xffff0000, v180
    v_lshlrev_b32 v78, 16, v182
    v_and_b32 v79, 0xffff0000, v182
    v_pk_mul_f32 v[72:73], v[72:73], v[152:153]
    v_pk_mul_f32 v[74:75], v[74:75], v[154:155]
    v_pk_mul_f32 v[76:77], v[76:77], v[156:157]
    v_pk_mul_f32 v[78:79], v[78:79], v[158:159]
    v_cvt_pk_bf16_f32 v202, v72, v73
    v_cvt_pk_bf16_f32 v203, v74, v75
    v_cvt_pk_bf16_f32 v206, v76, v77
    v_cvt_pk_bf16_f32 v207, v78, v79
    s_add_u32 s54, s49, 8192
    buffer_store_dwordx4 v[200:203], v8, s[24:27], s54 offen offset:0 sc1
    buffer_store_dwordx4 v[204:207], v8, s[24:27], s54 offen offset:1024 sc1
    s_waitcnt vmcnt(2)
    v_lshlrev_b32 v176, 16, v136
    v_and_b32 v177, 0xffff0000, v136
    v_lshlrev_b32 v178, 16, v137
    v_and_b32 v179, 0xffff0000, v137
    v_lshlrev_b32 v180, 16, v138
    v_and_b32 v181, 0xffff0000, v138
    v_lshlrev_b32 v182, 16, v139
    v_and_b32 v183, 0xffff0000, v139
    v_pk_add_f32 v[80:81], v[80:81], v[176:177]
    v_pk_add_f32 v[82:83], v[82:83], v[178:179]
    v_pk_add_f32 v[84:85], v[84:85], v[180:181]
    v_pk_add_f32 v[86:87], v[86:87], v[182:183]
    v_cvt_pk_bf16_f32 v176, v80, v81
    v_cvt_pk_bf16_f32 v178, v82, v83
    v_cvt_pk_bf16_f32 v180, v84, v85
    v_cvt_pk_bf16_f32 v182, v86, v87
    v_lshlrev_b32 v80, 16, v176
    v_and_b32 v81, 0xffff0000, v176
    v_lshlrev_b32 v82, 16, v178
    v_and_b32 v83, 0xffff0000, v178
    v_lshlrev_b32 v84, 16, v180
    v_and_b32 v85, 0xffff0000, v180
    v_lshlrev_b32 v86, 16, v182
    v_and_b32 v87, 0xffff0000, v182
    v_pk_add_f32 v[80:81], v[80:81], v[28:29] op_sel:[0,0] op_sel_hi:[1,0]
    v_pk_add_f32 v[82:83], v[82:83], v[28:29] op_sel:[0,0] op_sel_hi:[1,0]
    v_pk_add_f32 v[84:85], v[84:85], v[30:31] op_sel:[0,0] op_sel_hi:[1,0]
    v_pk_add_f32 v[86:87], v[86:87], v[30:31] op_sel:[0,0] op_sel_hi:[1,0]
    v_cvt_pk_bf16_f32 v176, v80, v81
    v_cvt_pk_bf16_f32 v178, v82, v83
    v_cvt_pk_bf16_f32 v180, v84, v85
    v_cvt_pk_bf16_f32 v182, v86, v87
    v_lshlrev_b32 v80, 16, v176
    v_and_b32 v81, 0xffff0000, v176
    v_lshlrev_b32 v82, 16, v178
    v_and_b32 v83, 0xffff0000, v178
    v_lshlrev_b32 v84, 16, v180
    v_and_b32 v85, 0xffff0000, v180
    v_lshlrev_b32 v86, 16, v182
    v_and_b32 v87, 0xffff0000, v182
    v_pk_mul_f32 v[80:81], v[80:81], v[160:161]
    v_pk_mul_f32 v[82:83], v[82:83], v[162:163]
    v_pk_mul_f32 v[84:85], v[84:85], v[164:165]
    v_pk_mul_f32 v[86:87], v[86:87], v[166:167]
    v_cvt_pk_bf16_f32 v208, v80, v81
    v_cvt_pk_bf16_f32 v209, v82, v83
    v_cvt_pk_bf16_f32 v212, v84, v85
    v_cvt_pk_bf16_f32 v213, v86, v87
    buffer_store_dwordx2 v[208:209], v9, s[24:27], s52 offen offset:0 sc1
    buffer_store_dwordx2 v[212:213], v9, s[24:27], s52 offen offset:1024 sc1
MD_ed:
    s_waitcnt vmcnt(0)
    s_mov_b64 exec, 1
    global_store_dword v5, v6, s[6:7] sc1
    s_mov_b64 exec, -1
    s_barrier
    s_cmp_lg_u32 s3, 0
    s_cbranch_scc1 M_e
MD_fp:
    global_load_dword v10, v7, s[6:7] sc1
    s_waitcnt vmcnt(0)
    v_cmp_ne_u32 vcc, 1, v10
    s_nop 3
    s_cbranch_vccz M_e
    s_sleep 3
    s_branch MD_fp
M_e:
    s_lshr_b32 s15, s3, 2
    s_mul_i32 s16, s38, 114688
    s_add_u32 s24, s6, s16
    s_addc_u32 s25, s7, 0
    s_add_u32 s24, s24, 36044800
    s_addc_u32 s25, s25, 0
    s_mov_b32 s26, 114688
    s_mov_b32 s27, 0x00020000
    s_lshl_b32 s44, s12, 10
    s_mul_i32 s16, s15, 57344
    s_add_u32 s44, s44, s16
    v_lshlrev_b32 v9, 3, v1
    s_lshl_b32 s53, s38, 2
    s_add_u32 s53, s53, s12
    s_mul_i32 s48, s53, 20480
    s_mul_i32 s49, s36, 5
    s_mul_i32 s16, s15, 71680
    s_add_u32 s16, s16, 59392
    v_add_u32 v20, s16, v8
    s_cmp_eq_u32 s15, 0
    s_mov_b32 s16, 2048
    s_cselect_b32 s16, 86016, s16
    v_add_u32 v21, s16, v8
    s_mul_i32 s51, s15, 3
    s_add_u32 s49, s49, s51
    s_barrier
    buffer_load_dwordx4 v[32:35], v8, s[24:27], s44 offen sc1
    s_add_u32 s44, s44, 4096
    buffer_load_dwordx4 v[40:43], v8, s[24:27], s44 offen sc1
    s_add_u32 s44, s44, 4096
    buffer_load_dwordx4 v[48:51], v8, s[24:27], s44 offen sc1
    s_add_u32 s44, s44, 4096
    buffer_load_dwordx4 v[56:59], v8, s[24:27], s44 offen sc1
    s_add_u32 s44, s44, 4096
    buffer_load_dwordx4 v[64:67], v8, s[24:27], s44 offen sc1
    s_add_u32 s44, s44, 4096
    ds_read_b128 v[164:167], v20 offset:0
    ds_read_b128 v[168:171], v20 offset:1024
    ds_read_b128 v[172:175], v20 offset:2048
    ds_read_b128 v[176:179], v20 offset:3072
    ds_read_b128 v[180:183], v20 offset:4096
    v_mul_u32_u24 v10, 1280, v3
    v_lshl_add_u32 v10, v4, 3, v10
    s_waitcnt vmcnt(4) lgkmcnt(0)
    v_mfma_f32_16x16x32_bf16 v[144:147], v[32:35], v[164:167], 0
    ds_read_b128 v[184:187], v20 offset:5120
    ds_read_b128 v[188:191], v20 offset:6144
    v_mfma_f32_16x16x32_bf16 v[148:151], v[32:35], v[168:171], 0
    ds_read_b128 v[192:195], v20 offset:7168
    v_mfma_f32_16x16x32_bf16 v[152:155], v[32:35], v[172:175], 0
    ds_read_b128 v[196:199], v20 offset:8192
    v_mfma_f32_16x16x32_bf16 v[156:159], v[32:35], v[176:179], 0
    ds_read_b128 v[200:203], v20 offset:9216
    v_mfma_f32_16x16x32_bf16 v[160:163], v[32:35], v[180:183], 0
    buffer_load_dwordx4 v[72:75], v8, s[24:27], s44 offen sc1
    s_add_u32 s44, s44, 4096
    s_waitcnt vmcnt(4) lgkmcnt(0)
    v_mfma_f32_16x16x32_bf16 v[144:147], v[40:43], v[184:187], v[144:147]
    ds_read_b128 v[164:167], v20 offset:10240
    ds_read_b128 v[168:171], v20 offset:11264
    v_mfma_f32_16x16x32_bf16 v[148:151], v[40:43], v[188:191], v[148:151]
    ds_read_b128 v[172:175], v20 offset:12288
    v_mfma_f32_16x16x32_bf16 v[152:155], v[40:43], v[192:195], v[152:155]
    ds_read_b128 v[176:179], v20 offset:13312
    v_mfma_f32_16x16x32_bf16 v[156:159], v[40:43], v[196:199], v[156:159]
    ds_read_b128 v[180:183], v20 offset:14336
    v_mfma_f32_16x16x32_bf16 v[160:163], v[40:43], v[200:203], v[160:163]
    buffer_load_dwordx2 v[80:81], v9, s[24:27], s44 offen sc1
    buffer_load_dwordx2 v[82:83], v9, s[24:27], s44 offen offset:512 sc1
    s_add_u32 s44, s44, 4096
    s_waitcnt vmcnt(5) lgkmcnt(0)
    v_mfma_f32_16x16x32_bf16 v[144:147], v[48:51], v[164:167], v[144:147]
    ds_read_b128 v[184:187], v20 offset:15360
    ds_read_b128 v[188:191], v20 offset:16384
    v_mfma_f32_16x16x32_bf16 v[148:151], v[48:51], v[168:171], v[148:151]
    ds_read_b128 v[192:195], v20 offset:17408
    v_mfma_f32_16x16x32_bf16 v[152:155], v[48:51], v[172:175], v[152:155]
    ds_read_b128 v[196:199], v20 offset:18432
    v_mfma_f32_16x16x32_bf16 v[156:159], v[48:51], v[176:179], v[156:159]
    ds_read_b128 v[200:203], v20 offset:19456
    v_mfma_f32_16x16x32_bf16 v[160:163], v[48:51], v[180:183], v[160:163]
    buffer_load_dwordx4 v[88:91], v8, s[24:27], s44 offen sc1
    s_add_u32 s44, s44, 4096
    s_waitcnt vmcnt(5) lgkmcnt(0)
    v_mfma_f32_16x16x32_bf16 v[144:147], v[56:59], v[184:187], v[144:147]
    ds_read_b128 v[164:167], v20 offset:20480
    ds_read_b128 v[168:171], v20 offset:21504
    v_mfma_f32_16x16x32_bf16 v[148:151], v[56:59], v[188:191], v[148:151]
    ds_read_b128 v[172:175], v20 offset:22528
    v_mfma_f32_16x16x32_bf16 v[152:155], v[56:59], v[192:195], v[152:155]
    ds_read_b128 v[176:179], v20 offset:23552
    v_mfma_f32_16x16x32_bf16 v[156:159], v[56:59], v[196:199], v[156:159]
    ds_read_b128 v[180:183], v20 offset:24576
    v_mfma_f32_16x16x32_bf16 v[160:163], v[56:59], v[200:203], v[160:163]
    buffer_load_dwordx4 v[96:99], v8, s[24:27], s44 offen sc1
    s_add_u32 s44, s44, 4096
    s_waitcnt vmcnt(5) lgkmcnt(0)
    v_mfma_f32_16x16x32_bf16 v[144:147], v[64:67], v[164:167], v[144:147]
    ds_read_b128 v[184:187], v20 offset:25600
    ds_read_b128 v[188:191], v21 offset:0
    v_mfma_f32_16x16x32_bf16 v[148:151], v[64:67], v[168:171], v[148:151]
    ds_read_b128 v[192:195], v21 offset:1024
    v_mfma_f32_16x16x32_bf16 v[152:155], v[64:67], v[172:175], v[152:155]
    ds_read_b128 v[196:199], v21 offset:2048
    v_mfma_f32_16x16x32_bf16 v[156:159], v[64:67], v[176:179], v[156:159]
    ds_read_b128 v[200:203], v21 offset:3072
    v_mfma_f32_16x16x32_bf16 v[160:163], v[64:67], v[180:183], v[160:163]
    buffer_load_dwordx4 v[104:107], v8, s[24:27], s44 offen sc1
    s_add_u32 s44, s44, 4096
    s_waitcnt vmcnt(5) lgkmcnt(0)
    v_mfma_f32_16x16x32_bf16 v[144:147], v[72:75], v[184:187], v[144:147]
    ds_read_b128 v[164:167], v21 offset:4096
    ds_read_b128 v[168:171], v21 offset:5120
    v_mfma_f32_16x16x32_bf16 v[148:151], v[72:75], v[188:191], v[148:151]
    ds_read_b128 v[172:175], v21 offset:6144
    v_mfma_f32_16x16x32_bf16 v[152:155], v[72:75], v[192:195], v[152:155]
    ds_read_b128 v[176:179], v21 offset:7168
    v_mfma_f32_16x16x32_bf16 v[156:159], v[72:75], v[196:199], v[156:159]
    ds_read_b128 v[180:183], v21 offset:8192
    v_mfma_f32_16x16x32_bf16 v[160:163], v[72:75], v[200:203], v[160:163]
    buffer_load_dwordx4 v[112:115], v8, s[24:27], s44 offen sc1
    s_add_u32 s44, s44, 4096
    s_waitcnt vmcnt(4) lgkmcnt(0)
    v_mfma_f32_16x16x32_bf16 v[144:147], v[80:83], v[164:167], v[144:147]
    ds_read_b128 v[184:187], v21 offset:9216
    ds_read_b128 v[188:191], v21 offset:10240
    v_mfma_f32_16x16x32_bf16 v[148:151], v[80:83], v[168:171], v[148:151]
    ds_read_b128 v[192:195], v21 offset:11264
    v_mfma_f32_16x16x32_bf16 v[152:155], v[80:83], v[172:175], v[152:155]
    ds_read_b128 v[196:199], v21 offset:12288
    v_mfma_f32_16x16x32_bf16 v[156:159], v[80:83], v[176:179], v[156:159]
    ds_read_b128 v[200:203], v21 offset:13312
    v_mfma_f32_16x16x32_bf16 v[160:163], v[80:83], v[180:183], v[160:163]
    buffer_load_dwordx4 v[120:123], v8, s[24:27], s44 offen sc1
    s_add_u32 s44, s44, 4096
    s_waitcnt vmcnt(4) lgkmcnt(0)
    v_mfma_f32_16x16x32_bf16 v[144:147], v[88:91], v[184:187], v[144:147]
    ds_read_b128 v[164:167], v21 offset:14336
    ds_read_b128 v[168:171], v21 offset:15360
    v_mfma_f32_16x16x32_bf16 v[148:151], v[88:91], v[188:191], v[148:151]
    ds_read_b128 v[172:175], v21 offset:16384
    v_mfma_f32_16x16x32_bf16 v[152:155], v[88:91], v[192:195], v[152:155]
    ds_read_b128 v[176:179], v21 offset:17408
    v_mfma_f32_16x16x32_bf16 v[156:159], v[88:91], v[196:199], v[156:159]
    ds_read_b128 v[180:183], v21 offset:18432
    v_mfma_f32_16x16x32_bf16 v[160:163], v[88:91], v[200:203], v[160:163]
    buffer_load_dwordx4 v[128:131], v8, s[24:27], s44 offen sc1
    s_add_u32 s44, s44, 4096
    s_waitcnt vmcnt(4) lgkmcnt(0)
    v_mfma_f32_16x16x32_bf16 v[144:147], v[96:99], v[164:167], v[144:147]
    ds_read_b128 v[184:187], v21 offset:19456
    ds_read_b128 v[188:191], v21 offset:20480
    v_mfma_f32_16x16x32_bf16 v[148:151], v[96:99], v[168:171], v[148:151]
    ds_read_b128 v[192:195], v21 offset:21504
    v_mfma_f32_16x16x32_bf16 v[152:155], v[96:99], v[172:175], v[152:155]
    ds_read_b128 v[196:199], v21 offset:22528
    v_mfma_f32_16x16x32_bf16 v[156:159], v[96:99], v[176:179], v[156:159]
    ds_read_b128 v[200:203], v21 offset:23552
    v_mfma_f32_16x16x32_bf16 v[160:163], v[96:99], v[180:183], v[160:163]
    buffer_load_dwordx2 v[136:137], v9, s[24:27], s44 offen sc1
    buffer_load_dwordx2 v[138:139], v9, s[24:27], s44 offen offset:512 sc1
    s_add_u32 s44, s44, 4096
    s_waitcnt vmcnt(5) lgkmcnt(0)
    v_mfma_f32_16x16x32_bf16 v[144:147], v[104:107], v[184:187], v[144:147]
    ds_read_b128 v[164:167], v21 offset:24576
    ds_read_b128 v[168:171], v21 offset:25600
    v_mfma_f32_16x16x32_bf16 v[148:151], v[104:107], v[188:191], v[148:151]
    ds_read_b128 v[172:175], v21 offset:26624
    v_mfma_f32_16x16x32_bf16 v[152:155], v[104:107], v[192:195], v[152:155]
    ds_read_b128 v[176:179], v21 offset:27648
    v_mfma_f32_16x16x32_bf16 v[156:159], v[104:107], v[196:199], v[156:159]
    ds_read_b128 v[180:183], v21 offset:28672
    v_mfma_f32_16x16x32_bf16 v[160:163], v[104:107], v[200:203], v[160:163]
    s_waitcnt vmcnt(4) lgkmcnt(0)
    v_mfma_f32_16x16x32_bf16 v[144:147], v[112:115], v[164:167], v[144:147]
    ds_read_b128 v[184:187], v21 offset:29696
    ds_read_b128 v[188:191], v21 offset:30720
    v_mfma_f32_16x16x32_bf16 v[148:151], v[112:115], v[168:171], v[148:151]
    ds_read_b128 v[192:195], v21 offset:31744
    v_mfma_f32_16x16x32_bf16 v[152:155], v[112:115], v[172:175], v[152:155]
    ds_read_b128 v[196:199], v21 offset:32768
    v_mfma_f32_16x16x32_bf16 v[156:159], v[112:115], v[176:179], v[156:159]
    ds_read_b128 v[200:203], v21 offset:33792
    v_mfma_f32_16x16x32_bf16 v[160:163], v[112:115], v[180:183], v[160:163]
    s_waitcnt vmcnt(3) lgkmcnt(0)
    v_mfma_f32_16x16x32_bf16 v[144:147], v[120:123], v[184:187], v[144:147]
    ds_read_b128 v[164:167], v21 offset:34816
    ds_read_b128 v[168:171], v21 offset:35840
    v_mfma_f32_16x16x32_bf16 v[148:151], v[120:123], v[188:191], v[148:151]
    ds_read_b128 v[172:175], v21 offset:36864
    v_mfma_f32_16x16x32_bf16 v[152:155], v[120:123], v[192:195], v[152:155]
    ds_read_b128 v[176:179], v21 offset:37888
    v_mfma_f32_16x16x32_bf16 v[156:159], v[120:123], v[196:199], v[156:159]
    ds_read_b128 v[180:183], v21 offset:38912
    v_mfma_f32_16x16x32_bf16 v[160:163], v[120:123], v[200:203], v[160:163]
    s_waitcnt vmcnt(2) lgkmcnt(0)
    v_mfma_f32_16x16x32_bf16 v[144:147], v[128:131], v[164:167], v[144:147]
    ds_read_b128 v[184:187], v21 offset:39936
    ds_read_b128 v[188:191], v21 offset:40960
    v_mfma_f32_16x16x32_bf16 v[148:151], v[128:131], v[168:171], v[148:151]
    ds_read_b128 v[192:195], v21 offset:41984
    v_mfma_f32_16x16x32_bf16 v[152:155], v[128:131], v[172:175], v[152:155]
    ds_read_b128 v[196:199], v21 offset:43008
    v_mfma_f32_16x16x32_bf16 v[156:159], v[128:131], v[176:179], v[156:159]
    ds_read_b128 v[200:203], v21 offset:44032
    v_mfma_f32_16x16x32_bf16 v[160:163], v[128:131], v[180:183], v[160:163]
    s_waitcnt vmcnt(0) lgkmcnt(0)
    v_mfma_f32_16x16x32_bf16 v[144:147], v[136:139], v[184:187], v[144:147]
    v_mfma_f32_16x16x32_bf16 v[148:151], v[136:139], v[188:191], v[148:151]
    v_mfma_f32_16x16x32_bf16 v[152:155], v[136:139], v[192:195], v[152:155]
    v_mfma_f32_16x16x32_bf16 v[156:159], v[136:139], v[196:199], v[156:159]
    v_mfma_f32_16x16x32_bf16 v[160:163], v[136:139], v[200:203], v[160:163]
    s_mul_i32 s16, s12, 5120
    s_add_u32 s16, s16, 2048
    v_add_u32 v20, s16, v8
    s_barrier
    s_cmp_eq_u32 s15, 0
    s_nop 0
    s_cbranch_scc1 ME_r0
    ds_write_b128 v20, v[144:147] offset:0
    ds_write_b128 v20, v[148:151] offset:1024
    ds_write_b128 v20, v[152:155] offset:2048
    s_branch ME_r1
ME_r0:
    ds_write_b128 v20, v[156:159] offset:3072
    ds_write_b128 v20, v[160:163] offset:4096
ME_r1:
    s_mov_b32 s16, s100
    s_mov_b32 s17, s101
    s_mov_b32 s18, 2621440
    s_mov_b32 s19, 0x00020000
    s_mul_i32 s50, s53, 20480
    s_lshl_b32 s51, s49, 5
    s_add_u32 s50, s50, s51
    s_lshl_b32 s51, s3, 11
    s_add_u32 s51, s51, 22528
    v_mul_u32_u24 v12, 40, v3
    v_lshl_add_u32 v12, v4, 3, v12
    v_add_u32 v12, s51, v12
    v_bfe_u32 v13, v1, 2, 4
    v_mul_u32_u24 v13, 40, v13
    v_and_b32 v14, 3, v1
    v_lshl_add_u32 v13, v14, 3, v13
    v_add_u32 v13, s51, v13
    s_waitcnt vmcnt(0) lgkmcnt(0)
    s_barrier
    s_cmp_eq_u32 s15, 0
    s_cbranch_scc0 ME_f1
    ds_read_b128 v[32:35], v20 offset:0
    ds_read_b128 v[36:39], v20 offset:1024
    ds_read_b128 v[40:43], v20 offset:2048
    s_waitcnt lgkmcnt(2)
    v_pk_add_f32 v[144:145], v[144:145], v[32:33]
    v_pk_add_f32 v[146:147], v[146:147], v[34:35]
    v_cvt_pk_bf16_f32 v144, v144, v145
    v_cvt_pk_bf16_f32 v146, v146, v147
    v_and_b32 v145, 0xffff0000, v144
    v_lshlrev_b32 v144, 16, v144
    v_lshlrev_b32 v64, 16, v16
    v_and_b32 v65, 0xffff0000, v16
    v_and_b32 v147, 0xffff0000, v146
    v_lshlrev_b32 v146, 16, v146
    v_lshlrev_b32 v66, 16, v17
    v_and_b32 v67, 0xffff0000, v17
    v_pk_add_f32 v[144:145], v[144:145], v[64:65]
    v_pk_add_f32 v[146:147], v[146:147], v[66:67]
    v_cvt_pk_bf16_f32 v68, v144, v145
    v_cvt_pk_bf16_f32 v69, v146, v147
    ds_write_b64 v12, v[68:69] offset:0
    s_waitcnt lgkmcnt(1)
    v_pk_add_f32 v[148:149], v[148:149], v[36:37]
    v_pk_add_f32 v[150:151], v[150:151], v[38:39]
    v_cvt_pk_bf16_f32 v148, v148, v149
    v_cvt_pk_bf16_f32 v150, v150, v151
    v_and_b32 v149, 0xffff0000, v148
    v_lshlrev_b32 v148, 16, v148
    v_lshlrev_b32 v72, 16, v18
    v_and_b32 v73, 0xffff0000, v18
    v_and_b32 v151, 0xffff0000, v150
    v_lshlrev_b32 v150, 16, v150
    v_lshlrev_b32 v74, 16, v19
    v_and_b32 v75, 0xffff0000, v19
    v_pk_add_f32 v[148:149], v[148:149], v[72:73]
    v_pk_add_f32 v[150:151], v[150:151], v[74:75]
    v_cvt_pk_bf16_f32 v76, v148, v149
    v_cvt_pk_bf16_f32 v77, v150, v151
    ds_write_b64 v12, v[76:77] offset:640
    s_waitcnt lgkmcnt(0)
    v_pk_add_f32 v[152:153], v[152:153], v[40:41]
    v_pk_add_f32 v[154:155], v[154:155], v[42:43]
    v_cvt_pk_bf16_f32 v152, v152, v153
    v_cvt_pk_bf16_f32 v154, v154, v155
    v_and_b32 v153, 0xffff0000, v152
    v_lshlrev_b32 v152, 16, v152
    v_lshlrev_b32 v80, 16, v26
    v_and_b32 v81, 0xffff0000, v26
    v_and_b32 v155, 0xffff0000, v154
    v_lshlrev_b32 v154, 16, v154
    v_lshlrev_b32 v82, 16, v27
    v_and_b32 v83, 0xffff0000, v27
    v_pk_add_f32 v[152:153], v[152:153], v[80:81]
    v_pk_add_f32 v[154:155], v[154:155], v[82:83]
    v_cvt_pk_bf16_f32 v84, v152, v153
    v_cvt_pk_bf16_f32 v85, v154, v155
    ds_write_b64 v12, v[84:85] offset:1280
    s_waitcnt lgkmcnt(0)
    ds_read_b64_tr_b16 v[32:33], v13 offset:0
    ds_read_b64_tr_b16 v[34:35], v13 offset:640
    ds_read_b64_tr_b16 v[36:37], v13 offset:1280
    s_waitcnt lgkmcnt(2)
    buffer_store_dwordx2 v[32:33], v10, s[16:19], s50 offen offset:0
    s_waitcnt lgkmcnt(1)
    buffer_store_dwordx2 v[34:35], v10, s[16:19], s50 offen offset:32
    s_waitcnt lgkmcnt(0)
    buffer_store_dwordx2 v[36:37], v10, s[16:19], s50 offen offset:64
    s_branch ME_fin
ME_f1:
    ds_read_b128 v[44:47], v20 offset:3072
    ds_read_b128 v[48:51], v20 offset:4096
    s_waitcnt lgkmcnt(1)
    v_pk_add_f32 v[156:157], v[156:157], v[44:45]
    v_pk_add_f32 v[158:159], v[158:159], v[46:47]
    v_cvt_pk_bf16_f32 v156, v156, v157
    v_cvt_pk_bf16_f32 v158, v158, v159
    v_and_b32 v157, 0xffff0000, v156
    v_lshlrev_b32 v156, 16, v156
    v_lshlrev_b32 v88, 16, v16
    v_and_b32 v89, 0xffff0000, v16
    v_and_b32 v159, 0xffff0000, v158
    v_lshlrev_b32 v158, 16, v158
    v_lshlrev_b32 v90, 16, v17
    v_and_b32 v91, 0xffff0000, v17
    v_pk_add_f32 v[156:157], v[156:157], v[88:89]
    v_pk_add_f32 v[158:159], v[158:159], v[90:91]
    v_cvt_pk_bf16_f32 v92, v156, v157
    v_cvt_pk_bf16_f32 v93, v158, v159
    ds_write_b64 v12, v[92:93] offset:0
    s_waitcnt lgkmcnt(0)
    v_pk_add_f32 v[160:161], v[160:161], v[48:49]
    v_pk_add_f32 v[162:163], v[162:163], v[50:51]
    v_cvt_pk_bf16_f32 v160, v160, v161
    v_cvt_pk_bf16_f32 v162, v162, v163
    v_and_b32 v161, 0xffff0000, v160
    v_lshlrev_b32 v160, 16, v160
    v_lshlrev_b32 v96, 16, v18
    v_and_b32 v97, 0xffff0000, v18
    v_and_b32 v163, 0xffff0000, v162
    v_lshlrev_b32 v162, 16, v162
    v_lshlrev_b32 v98, 16, v19
    v_and_b32 v99, 0xffff0000, v19
    v_pk_add_f32 v[160:161], v[160:161], v[96:97]
    v_pk_add_f32 v[162:163], v[162:163], v[98:99]
    v_cvt_pk_bf16_f32 v100, v160, v161
    v_cvt_pk_bf16_f32 v101, v162, v163
    ds_write_b64 v12, v[100:101] offset:640
    s_waitcnt lgkmcnt(0)
    ds_read_b64_tr_b16 v[32:33], v13 offset:0
    ds_read_b64_tr_b16 v[34:35], v13 offset:640
    s_waitcnt lgkmcnt(1)
    buffer_store_dwordx2 v[32:33], v10, s[16:19], s50 offen offset:0
    s_waitcnt lgkmcnt(0)
    buffer_store_dwordx2 v[34:35], v10, s[16:19], s50 offen offset:32
ME_fin:
M_end:
    s_endpgm
M_codeend:
.fill 256, 4, 0xBF800000
.section .rodata,"a"
.p2align 6
.amdhsa_kernel prep_kernel
  .amdhsa_next_free_vgpr 168
  .amdhsa_next_free_sgpr 96
  .amdhsa_accum_offset 168
  .amdhsa_group_segment_fixed_size 0
  .amdhsa_kernarg_size 120
  .amdhsa_user_sgpr_count 2
  .amdhsa_user_sgpr_kernarg_segment_ptr 1
  .amdhsa_system_sgpr_workgroup_id_x 1
  .amdhsa_float_denorm_mode_32 3
.end_amdhsa_kernel
.section .rodata,"a"
.p2align 6
.amdhsa_kernel main_kernel
  .amdhsa_next_free_vgpr 256
  .amdhsa_next_free_sgpr 102
  .amdhsa_accum_offset 256
  .amdhsa_group_segment_fixed_size 0
  .amdhsa_kernarg_size 120
  .amdhsa_user_sgpr_count 2
  .amdhsa_user_sgpr_kernarg_segment_ptr 1
  .amdhsa_system_sgpr_workgroup_id_x 1
  .amdhsa_float_denorm_mode_32 3
.end_amdhsa_kernel
```
